```python
import torch

def _softmax(x, axis=-1):
    return torch.softmax(x, dim=axis)
def _gelu(x):
    return torch.nn.functional.gelu(x, approximate="tanh")
def _silu(x):
    return torch.nn.functional.silu(x)
def _sigmoid(x):
    return torch.sigmoid(x)
def _layernorm(x, axis=-1, eps=1e-5):
    m = x.mean(dim=axis, keepdim=True)
    v = x.var(dim=axis, keepdim=True, unbiased=False)
    return (x - m) / torch.sqrt(v + eps)
def _scatter_add(tgt, idx, src, axis=0):
    return tgt.clone().index_add_(axis, idx, src)
def _segment_sum(src, seg, n):
    out = torch.zeros((n,) + src.shape[1:], dtype=src.dtype)
    return out.index_add_(0, seg, src)
def _pad(x, pw):
    flat = tuple(v for pair in reversed(pw) for v in pair)
    return torch.nn.functional.pad(x, flat)

kernel_name = 'gated_mix__sliding_block_cached__dense_activation_silu__decode'

def setup_inputs():

    _w = (lambda a: (lambda t: t.to(torch.bfloat16) if t.is_floating_point() else t)(torch.as_tensor(a)))
    def _A_setup():
        B, Sq, D = 2, 1, 512
        Hq, Hkv, Sk, Dh = 32, 8, 32768, 128
        assert Hq % Hkv == 0, (Hq, Hkv)
        return {
            "x": _w((lambda *s: torch.randn(*s, dtype=torch.bfloat16) * 0.05)(B, Sq, D)),
            "k_cache": _w((lambda *s: torch.randn(*s, dtype=torch.bfloat16) * 6.4)(B, Hkv, Sk, Dh)),
            "v_cache": _w((lambda *s: torch.randn(*s, dtype=torch.bfloat16) * 0.8)(B, Hkv, Sk, Dh)),
            "wq": _w((lambda *s: torch.randn(*s, dtype=torch.bfloat16) * 6.4)(D, Hq * Dh) * (D ** -0.5)),
            "wo": _w((lambda *s: torch.randn(*s, dtype=torch.bfloat16) * 0.8)(Hq * Dh, D) * ((Hq * Dh) ** -0.5)),
        }
    _A_in = _A_setup()

    def _B_setup():
        B, S, D, F = 2, 1, 512, 1792
        return {
            "x": _w((lambda *s: torch.randn(*s, dtype=torch.bfloat16) * 0.05)(B, S, D)),
            "w1": _w((lambda *s: torch.randn(*s, dtype=torch.bfloat16) * 12.8)(D, F) * (D ** -0.5)),
            "w2": _w((lambda *s: torch.randn(*s, dtype=torch.bfloat16) * 0.4)(F, D) * (F ** -0.5)),
        }
    _B_in = _B_setup()

    return {
        "A_x": _A_in["x"],
        "A_k_cache": _A_in["k_cache"],
        "A_v_cache": _A_in["v_cache"],
        "A_wq": _A_in["wq"],
        "A_wo": _A_in["wo"],
        "B_x": _B_in["x"],
        "B_w1": _B_in["w1"],
        "B_w2": _B_in["w2"],
        "gate_w": _w((lambda *s: torch.randn(*s, dtype=torch.bfloat16) * 0.05)(512) * 16.0),
    }

def reference(A_x, A_k_cache, A_v_cache, A_wq, A_wo, B_x, B_w1, B_w2, gate_w):
    def _A_ref(x, k_cache, v_cache, wq, wo):
        B, Sq, D = x.shape
        Hq, Dh = 32, 128
        Hkv, Sk = k_cache.shape[1], k_cache.shape[2]
        W = min(4096, max(256, Sk // 4))
        rep = Hq // Hkv
        q = (lambda x, *d: x.permute(*d))((x @ wq).reshape(B, Sq, Hq, Dh), 0, 2, 1, 3)
        k = (lambda x, n, axis: torch.repeat_interleave(x, n, dim=axis))(k_cache[:, :, Sk - W:, :], rep, axis=1)
        v = (lambda x, n, axis: torch.repeat_interleave(x, n, dim=axis))(v_cache[:, :, Sk - W:, :], rep, axis=1)
        scores = torch.einsum("bhqd,bhkd->bhqk", q, k) * (Dh ** -0.5)
        p = _softmax(scores, axis=-1)
        o = torch.einsum("bhqk,bhkd->bhqd", p, v)
        return (lambda x, *d: x.permute(*d))(o, 0, 2, 1, 3).reshape(B, Sq, Hq * Dh) @ wo

    def _B_ref(x, w1, w2):
        h = torch.einsum("bsd,df->bsf", x, w1)
        h = _silu(h)
        out = torch.einsum("bsf,fd->bsd", h, w2)
        return out

    x = A_x
    g = _sigmoid((x * gate_w).sum(-1, keepdims=True))
    a = _A_ref(x, A_k_cache, A_v_cache, A_wq, A_wo)
    b = _B_ref(x, B_w1, B_w2)
    return g * a + (1 - g) * b
```

```asm
; @launch grid=(256,1,1) block=(384,1,1) lds=159744
.amdgcn_target "amdgcn-amd-amdhsa--gfx950"
.text
.p2align 12
.fill 832, 4, 0xbf800000
.globl gated_mix__sliding_block_cached__dense_activation_silu__decode_kernel
.p2align 8
.type gated_mix__sliding_block_cached__dense_activation_silu__decode_kernel,@function
gated_mix__sliding_block_cached__dense_activation_silu__decode_kernel:
    s_cmp_ge_u32 s2, 256
    s_cbranch_scc1 L_end
    s_load_dwordx2 s[12:13], s[0:1], 8
    s_load_dwordx2 s[20:21], s[0:1], 24
    s_load_dwordx2 s[8:9], s[0:1], 0
    s_load_dwordx2 s[44:45], s[0:1], 88
    s_load_dwordx2 s[40:41], s[0:1], 72
    v_lshrrev_b32 v1, 6, v0
    s_and_b32 s48, s2, 7
    s_lshr_b32 s49, s2, 3
    v_readfirstlane_b32 s3, v1
    v_and_b32 v0, 63, v0
    s_nop 1
    s_cmp_eq_u32 s3, 2
    s_cbranch_scc1 L_p1q
    s_cmp_eq_u32 s3, 5
    s_cbranch_scc0 L_others
    s_mov_b32 s14, 0x8000000
    s_mov_b32 s15, 0x20000
    v_and_b32 v2, 15, v0
    v_lshrrev_b32 v3, 4, v0
    s_lshr_b32 s52, s49, 4
    s_lshl_b32 s54, s52, 3
    s_add_u32 s54, s54, s48
    s_lshl_b32 s54, s54, 23
    s_and_b32 s53, s49, 15
    s_lshl_b32 s55, s53, 16
    s_add_u32 s54, s54, s55
    s_add_u32 s54, s54, 7340032
    v_lshlrev_b32 v4, 8, v3
    v_xor_b32 v5, v3, v2
    v_lshl_add_u32 v20, v5, 4, v4
    v_xor_b32 v6, 4, v5
    v_lshl_add_u32 v21, v6, 4, v4
    v_xor_b32 v6, 8, v5
    v_lshl_add_u32 v22, v6, 4, v4
    v_xor_b32 v6, 12, v5
    v_lshl_add_u32 v23, v6, 4, v4
    s_mul_i32 s56, s49, 1
    s_waitcnt lgkmcnt(0)
    s_add_u32 s63, s56, 0
    s_and_b32 s63, s63, 15
    s_lshl_b32 s63, s63, 12
    s_add_u32 s63, s63, s54
    s_mov_b32 m0, 28672
    s_nop 0
    buffer_load_dwordx4 v20, s[12:15], s63 offen offset:0 nt lds
    buffer_load_dwordx4 v21, s[12:15], s63 offen offset:1024 nt lds
    buffer_load_dwordx4 v22, s[12:15], s63 offen offset:2048 nt lds
    buffer_load_dwordx4 v23, s[12:15], s63 offen offset:3072 nt lds
    s_add_u32 s63, s56, 1
    s_and_b32 s63, s63, 15
    s_lshl_b32 s63, s63, 12
    s_add_u32 s63, s63, s54
    s_mov_b32 m0, 32768
    s_nop 0
    buffer_load_dwordx4 v20, s[12:15], s63 offen offset:0 nt lds
    buffer_load_dwordx4 v21, s[12:15], s63 offen offset:1024 nt lds
    buffer_load_dwordx4 v22, s[12:15], s63 offen offset:2048 nt lds
    buffer_load_dwordx4 v23, s[12:15], s63 offen offset:3072 nt lds
    s_add_u32 s63, s56, 2
    s_and_b32 s63, s63, 15
    s_lshl_b32 s63, s63, 12
    s_add_u32 s63, s63, s54
    s_mov_b32 m0, 36864
    s_nop 0
    buffer_load_dwordx4 v20, s[12:15], s63 offen offset:0 nt lds
    buffer_load_dwordx4 v21, s[12:15], s63 offen offset:1024 nt lds
    buffer_load_dwordx4 v22, s[12:15], s63 offen offset:2048 nt lds
    buffer_load_dwordx4 v23, s[12:15], s63 offen offset:3072 nt lds
    s_branch L_loader_main

L_p1q:
    s_mov_b32 s22, 0x400000
    s_mov_b32 s23, 0x20000
    s_mov_b32 s10, 0x800
    s_mov_b32 s11, 0x20000
    s_and_b32 s52, s49, 7
    s_lshr_b32 s53, s49, 3
    s_lshl_b32 s56, s53, 20
    s_lshl_b32 s57, s48, 10
    s_lshl_b32 s58, s52, 7
    s_add_u32 s57, s57, s58
    s_add_u32 s56, s56, s57
    v_lshrrev_b32 v5, 3, v0
    v_and_b32 v6, 7, v0
    v_lshlrev_b32 v6, 4, v6
    v_lshlrev_b32 v7, 17, v5
    v_add_u32 v7, v7, v6
    v_lshlrev_b32 v9, 5, v5
    s_lshl_b32 s64, s53, 8
    s_movk_i32 s65, 0x2000

    s_waitcnt lgkmcnt(0)
    buffer_load_dwordx4 v[20:23], v9, s[8:11], s64 offen
    buffer_load_dwordx4 v[24:27], v9, s[8:11], s64 offen offset:16
    buffer_load_dwordx4 v[28:31], v9, s[8:11], s64 offen offset:1024
    buffer_load_dwordx4 v[32:35], v9, s[8:11], s64 offen offset:1040
    buffer_load_dwordx4 v[64:67], v7, s[20:23], s56 offen nt
    s_add_u32 s56, s56, s65
    buffer_load_dwordx4 v[68:71], v7, s[20:23], s56 offen nt
    s_add_u32 s56, s56, s65
    buffer_load_dwordx4 v[72:75], v7, s[20:23], s56 offen nt
    s_add_u32 s56, s56, s65
    buffer_load_dwordx4 v[76:79], v7, s[20:23], s56 offen nt
    s_add_u32 s56, s56, s65
    buffer_load_dwordx4 v[80:83], v7, s[20:23], s56 offen nt
    s_add_u32 s56, s56, s65
    buffer_load_dwordx4 v[84:87], v7, s[20:23], s56 offen nt
    s_add_u32 s56, s56, s65
    buffer_load_dwordx4 v[88:91], v7, s[20:23], s56 offen nt
    s_add_u32 s56, s56, s65
    buffer_load_dwordx4 v[92:95], v7, s[20:23], s56 offen nt
    s_add_u32 s56, s56, s65
    buffer_load_dwordx4 v[96:99], v7, s[20:23], s56 offen nt
    s_add_u32 s56, s56, s65
    buffer_load_dwordx4 v[100:103], v7, s[20:23], s56 offen nt
    s_add_u32 s56, s56, s65
    buffer_load_dwordx4 v[104:107], v7, s[20:23], s56 offen nt
    s_add_u32 s56, s56, s65
    buffer_load_dwordx4 v[108:111], v7, s[20:23], s56 offen nt
    s_add_u32 s56, s56, s65
    buffer_load_dwordx4 v[112:115], v7, s[20:23], s56 offen nt
    s_add_u32 s56, s56, s65
    buffer_load_dwordx4 v[116:119], v7, s[20:23], s56 offen nt
    s_add_u32 s56, s56, s65
    buffer_load_dwordx4 v[120:123], v7, s[20:23], s56 offen nt
    s_add_u32 s56, s56, s65
    buffer_load_dwordx4 v[124:127], v7, s[20:23], s56 offen nt
    s_load_dword s84, s[44:45], 0x0
    s_mov_b32 s46, 0x20000000
    s_mov_b32 s47, 0x20000
    s_mov_b32 s42, 0x800
    s_mov_b32 s43, 0x20000
    v_and_b32 v2, 15, v0
    v_lshrrev_b32 v3, 4, v0
    v_lshlrev_b32 v1, 2, v0
    s_lshr_b32 s50, s49, 2
    s_lshl_b32 s51, s48, 3
    s_add_u32 s50, s50, s51
    s_and_b32 s51, s49, 3
    s_mov_b32 s85, 0
    s_mov_b32 s86, 1048576
    s_mov_b32 s87, 0xff
    s_barrier
    v_and_b32 v4, 1, v0
    v_bfe_u32 v5, v0, 1, 2
    v_mov_b32 v6, 0x0c0c0100
    v_mov_b32 v8, 0x01000c0c
    v_cmp_eq_u32 vcc, 1, v4
    s_nop 1
    v_cndmask_b32 v6, v6, v8, vcc
    v_mov_b32 v8, 0x0c0c0302
    v_mov_b32 v10, 0x03020c0c
    v_cndmask_b32 v8, v8, v10, vcc
    v_mov_b32 v10, 0x0c0c0c0c
    v_cmp_eq_u32 vcc, 0, v5
    s_nop 1
    v_cndmask_b32 v136, v10, v6, vcc
    v_cndmask_b32 v137, v10, v8, vcc
    v_cmp_eq_u32 vcc, 1, v5
    s_nop 1
    v_cndmask_b32 v138, v10, v6, vcc
    v_cndmask_b32 v139, v10, v8, vcc
    v_cmp_eq_u32 vcc, 2, v5
    s_nop 1
    v_cndmask_b32 v140, v10, v6, vcc
    v_cndmask_b32 v141, v10, v8, vcc
    v_cmp_eq_u32 vcc, 3, v5
    s_nop 1
    v_cndmask_b32 v142, v10, v6, vcc
    v_cndmask_b32 v143, v10, v8, vcc
    s_waitcnt lgkmcnt(0)
    s_add_u32 s84, s84, 0x01010101
    s_and_b32 s80, s84, 0xff
    s_bfe_u32 s81, s84, 0x80008
    s_bfe_u32 s82, s84, 0x80010
    s_lshr_b32 s83, s84, 24
    v_mov_b32 v16, s80
    v_mov_b32 v17, s81
    v_mov_b32 v18, s82
    v_mov_b32 v19, s83
    s_lshl_b32 s72, s53, 15
    s_lshl_b32 s73, s57, 1
    s_add_u32 s72, s72, s73
    s_add_u32 s72, s72, 65536
    s_add_u32 s73, s72, 131072
    v_lshrrev_b32 v4, 5, v0
    v_lshlrev_b32 v4, 14, v4
    v_and_b32 v5, 7, v0
    v_lshl_add_u32 v4, v5, 5, v4
    v_bfe_u32 v5, v0, 4, 1
    v_lshl_add_u32 v4, v5, 4, v4
    s_mov_b32 s70, 0x00ff00ff
    s_mov_b32 s71, 0x00ff00ff
    v_mov_b32 v128, 0
    v_mov_b32 v129, 0
    v_mov_b32 v130, 0
    v_mov_b32 v131, 0
    v_mov_b32 v132, 0
    v_mov_b32 v133, 0
    v_mov_b32 v134, 0
    v_mov_b32 v135, 0
    s_waitcnt vmcnt(16)
    v_perm_b32 v48, v20, v20, v136
    v_perm_b32 v49, v20, v20, v138
    v_perm_b32 v50, v20, v20, v140
    v_perm_b32 v51, v20, v20, v142
    v_perm_b32 v52, v28, v28, v136
    v_perm_b32 v53, v28, v28, v138
    v_perm_b32 v54, v28, v28, v140
    v_perm_b32 v55, v28, v28, v142
    v_perm_b32 v56, v20, v20, v137
    v_perm_b32 v57, v20, v20, v139
    v_perm_b32 v58, v20, v20, v141
    v_perm_b32 v59, v20, v20, v143
    v_perm_b32 v60, v28, v28, v137
    v_perm_b32 v61, v28, v28, v139
    v_perm_b32 v62, v28, v28, v141
    v_perm_b32 v63, v28, v28, v143
    s_waitcnt vmcnt(15)
    v_mfma_f32_16x16x32_bf16 v[128:131], v[48:51], v[64:67], v[128:131]
    v_mfma_f32_16x16x32_bf16 v[132:135], v[52:55], v[64:67], v[132:135]
    v_perm_b32 v48, v21, v21, v136
    v_perm_b32 v49, v21, v21, v138
    v_perm_b32 v50, v21, v21, v140
    v_perm_b32 v51, v21, v21, v142
    v_perm_b32 v52, v29, v29, v136
    v_perm_b32 v53, v29, v29, v138
    v_perm_b32 v54, v29, v29, v140
    v_perm_b32 v55, v29, v29, v142
    s_waitcnt vmcnt(14)
    v_mfma_f32_16x16x32_bf16 v[128:131], v[56:59], v[68:71], v[128:131]
    v_mfma_f32_16x16x32_bf16 v[132:135], v[60:63], v[68:71], v[132:135]
    v_perm_b32 v56, v21, v21, v137
    v_perm_b32 v57, v21, v21, v139
    v_perm_b32 v58, v21, v21, v141
    v_perm_b32 v59, v21, v21, v143
    v_perm_b32 v60, v29, v29, v137
    v_perm_b32 v61, v29, v29, v139
    v_perm_b32 v62, v29, v29, v141
    v_perm_b32 v63, v29, v29, v143
    s_waitcnt vmcnt(13)
    v_mfma_f32_16x16x32_bf16 v[128:131], v[48:51], v[72:75], v[128:131]
    v_mfma_f32_16x16x32_bf16 v[132:135], v[52:55], v[72:75], v[132:135]
    v_perm_b32 v48, v22, v22, v136
    v_perm_b32 v49, v22, v22, v138
    v_perm_b32 v50, v22, v22, v140
    v_perm_b32 v51, v22, v22, v142
    v_perm_b32 v52, v30, v30, v136
    v_perm_b32 v53, v30, v30, v138
    v_perm_b32 v54, v30, v30, v140
    v_perm_b32 v55, v30, v30, v142
    s_waitcnt vmcnt(12)
    v_mfma_f32_16x16x32_bf16 v[128:131], v[56:59], v[76:79], v[128:131]
    v_mfma_f32_16x16x32_bf16 v[132:135], v[60:63], v[76:79], v[132:135]
    v_perm_b32 v56, v22, v22, v137
    v_perm_b32 v57, v22, v22, v139
    v_perm_b32 v58, v22, v22, v141
    v_perm_b32 v59, v22, v22, v143
    v_perm_b32 v60, v30, v30, v137
    v_perm_b32 v61, v30, v30, v139
    v_perm_b32 v62, v30, v30, v141
    v_perm_b32 v63, v30, v30, v143
    s_waitcnt vmcnt(11)
    v_mfma_f32_16x16x32_bf16 v[128:131], v[48:51], v[80:83], v[128:131]
    v_mfma_f32_16x16x32_bf16 v[132:135], v[52:55], v[80:83], v[132:135]
    v_perm_b32 v48, v23, v23, v136
    v_perm_b32 v49, v23, v23, v138
    v_perm_b32 v50, v23, v23, v140
    v_perm_b32 v51, v23, v23, v142
    v_perm_b32 v52, v31, v31, v136
    v_perm_b32 v53, v31, v31, v138
    v_perm_b32 v54, v31, v31, v140
    v_perm_b32 v55, v31, v31, v142
    s_waitcnt vmcnt(10)
    v_mfma_f32_16x16x32_bf16 v[128:131], v[56:59], v[84:87], v[128:131]
    v_mfma_f32_16x16x32_bf16 v[132:135], v[60:63], v[84:87], v[132:135]
    v_perm_b32 v56, v23, v23, v137
    v_perm_b32 v57, v23, v23, v139
    v_perm_b32 v58, v23, v23, v141
    v_perm_b32 v59, v23, v23, v143
    v_perm_b32 v60, v31, v31, v137
    v_perm_b32 v61, v31, v31, v139
    v_perm_b32 v62, v31, v31, v141
    v_perm_b32 v63, v31, v31, v143
    s_waitcnt vmcnt(9)
    v_mfma_f32_16x16x32_bf16 v[128:131], v[48:51], v[88:91], v[128:131]
    v_mfma_f32_16x16x32_bf16 v[132:135], v[52:55], v[88:91], v[132:135]
    v_perm_b32 v48, v24, v24, v136
    v_perm_b32 v49, v24, v24, v138
    v_perm_b32 v50, v24, v24, v140
    v_perm_b32 v51, v24, v24, v142
    v_perm_b32 v52, v32, v32, v136
    v_perm_b32 v53, v32, v32, v138
    v_perm_b32 v54, v32, v32, v140
    v_perm_b32 v55, v32, v32, v142
    s_waitcnt vmcnt(8)
    v_mfma_f32_16x16x32_bf16 v[128:131], v[56:59], v[92:95], v[128:131]
    v_mfma_f32_16x16x32_bf16 v[132:135], v[60:63], v[92:95], v[132:135]
    v_perm_b32 v56, v24, v24, v137
    v_perm_b32 v57, v24, v24, v139
    v_perm_b32 v58, v24, v24, v141
    v_perm_b32 v59, v24, v24, v143
    v_perm_b32 v60, v32, v32, v137
    v_perm_b32 v61, v32, v32, v139
    v_perm_b32 v62, v32, v32, v141
    v_perm_b32 v63, v32, v32, v143
    s_waitcnt vmcnt(7)
    v_mfma_f32_16x16x32_bf16 v[128:131], v[48:51], v[96:99], v[128:131]
    v_mfma_f32_16x16x32_bf16 v[132:135], v[52:55], v[96:99], v[132:135]
    v_perm_b32 v48, v25, v25, v136
    v_perm_b32 v49, v25, v25, v138
    v_perm_b32 v50, v25, v25, v140
    v_perm_b32 v51, v25, v25, v142
    v_perm_b32 v52, v33, v33, v136
    v_perm_b32 v53, v33, v33, v138
    v_perm_b32 v54, v33, v33, v140
    v_perm_b32 v55, v33, v33, v142
    s_waitcnt vmcnt(6)
    v_mfma_f32_16x16x32_bf16 v[128:131], v[56:59], v[100:103], v[128:131]
    v_mfma_f32_16x16x32_bf16 v[132:135], v[60:63], v[100:103], v[132:135]
    v_perm_b32 v56, v25, v25, v137
    v_perm_b32 v57, v25, v25, v139
    v_perm_b32 v58, v25, v25, v141
    v_perm_b32 v59, v25, v25, v143
    v_perm_b32 v60, v33, v33, v137
    v_perm_b32 v61, v33, v33, v139
    v_perm_b32 v62, v33, v33, v141
    v_perm_b32 v63, v33, v33, v143
    s_waitcnt vmcnt(5)
    v_mfma_f32_16x16x32_bf16 v[128:131], v[48:51], v[104:107], v[128:131]
    v_mfma_f32_16x16x32_bf16 v[132:135], v[52:55], v[104:107], v[132:135]
    v_perm_b32 v48, v26, v26, v136
    v_perm_b32 v49, v26, v26, v138
    v_perm_b32 v50, v26, v26, v140
    v_perm_b32 v51, v26, v26, v142
    v_perm_b32 v52, v34, v34, v136
    v_perm_b32 v53, v34, v34, v138
    v_perm_b32 v54, v34, v34, v140
    v_perm_b32 v55, v34, v34, v142
    s_waitcnt vmcnt(4)
    v_mfma_f32_16x16x32_bf16 v[128:131], v[56:59], v[108:111], v[128:131]
    v_mfma_f32_16x16x32_bf16 v[132:135], v[60:63], v[108:111], v[132:135]
    v_perm_b32 v56, v26, v26, v137
    v_perm_b32 v57, v26, v26, v139
    v_perm_b32 v58, v26, v26, v141
    v_perm_b32 v59, v26, v26, v143
    v_perm_b32 v60, v34, v34, v137
    v_perm_b32 v61, v34, v34, v139
    v_perm_b32 v62, v34, v34, v141
    v_perm_b32 v63, v34, v34, v143
    s_waitcnt vmcnt(3)
    v_mfma_f32_16x16x32_bf16 v[128:131], v[48:51], v[112:115], v[128:131]
    v_mfma_f32_16x16x32_bf16 v[132:135], v[52:55], v[112:115], v[132:135]
    v_perm_b32 v48, v27, v27, v136
    v_perm_b32 v49, v27, v27, v138
    v_perm_b32 v50, v27, v27, v140
    v_perm_b32 v51, v27, v27, v142
    v_perm_b32 v52, v35, v35, v136
    v_perm_b32 v53, v35, v35, v138
    v_perm_b32 v54, v35, v35, v140
    v_perm_b32 v55, v35, v35, v142
    s_waitcnt vmcnt(2)
    v_mfma_f32_16x16x32_bf16 v[128:131], v[56:59], v[116:119], v[128:131]
    v_mfma_f32_16x16x32_bf16 v[132:135], v[60:63], v[116:119], v[132:135]
    v_perm_b32 v56, v27, v27, v137
    v_perm_b32 v57, v27, v27, v139
    v_perm_b32 v58, v27, v27, v141
    v_perm_b32 v59, v27, v27, v143
    v_perm_b32 v60, v35, v35, v137
    v_perm_b32 v61, v35, v35, v139
    v_perm_b32 v62, v35, v35, v141
    v_perm_b32 v63, v35, v35, v143
    s_waitcnt vmcnt(1)
    v_mfma_f32_16x16x32_bf16 v[128:131], v[48:51], v[120:123], v[128:131]
    v_mfma_f32_16x16x32_bf16 v[132:135], v[52:55], v[120:123], v[132:135]
    s_waitcnt vmcnt(0)
    v_mfma_f32_16x16x32_bf16 v[128:131], v[56:59], v[124:127], v[128:131]
    v_mfma_f32_16x16x32_bf16 v[132:135], v[60:63], v[124:127], v[132:135]
    s_nop 7
    v_permlane32_swap_b32 v128, v132
    v_permlane32_swap_b32 v129, v133
    v_permlane32_swap_b32 v130, v134
    v_permlane32_swap_b32 v131, v135
    v_add_f32_dpp v36, v132, v128 row_ror:8 row_mask:0xf bank_mask:0xf
    v_add_f32_dpp v37, v133, v129 row_ror:8 row_mask:0xf bank_mask:0xf
    v_add_f32_dpp v38, v134, v130 row_ror:8 row_mask:0xf bank_mask:0xf
    v_add_f32_dpp v39, v135, v131 row_ror:8 row_mask:0xf bank_mask:0xf
    v_bfi_b32 v36, s87, v16, v36
    v_bfi_b32 v37, s87, v17, v37
    v_bfi_b32 v38, s87, v18, v38
    v_bfi_b32 v39, s87, v19, v39
    s_mov_b64 exec, s[70:71]
    buffer_store_dwordx4 v[36:39], v4, s[44:47], s72 offen
    buffer_store_dwordx4 v[36:39], v4, s[44:47], s73 offen sc1
    s_mov_b64 exec, -1
    v_mov_b32 v5, 1
    v_mov_b32 v4, 0
    ds_write_b32 v4, v5 offset:284

L_qwait:
    v_xor_b32 v9, v3, v2
    v_lshlrev_b32 v10, 8, v2
    s_lshl_b32 s72, s3, 12
    s_add_u32 s72, s72, 28672
    v_add_u32 v10, s72, v10
    v_xor_b32 v4, 0, v9
    v_lshl_add_u32 v20, v4, 4, v10
    v_xor_b32 v4, 4, v9
    v_lshl_add_u32 v21, v4, 4, v10
    v_xor_b32 v4, 8, v9
    v_lshl_add_u32 v22, v4, 4, v10
    v_xor_b32 v4, 12, v9
    v_lshl_add_u32 v23, v4, 4, v10
    v_and_b32 v8, 3, v0
    v_lshlrev_b32 v4, 4, v8
    v_lshlrev_b32 v8, 8, v8
    v_lshl_add_u32 v8, v3, 4, v8
    s_lshl_b32 s72, s3, 2
    v_add_u32 v5, s72, v4
    v_mov_b32 v9, 0
    v_mov_b32 v48, 0
    v_mov_b32 v49, 0
    v_mov_b32 v50, 0
    v_mov_b32 v51, 0
    v_mov_b32 v52, 0
    v_mov_b32 v53, 0
    v_mov_b32 v54, 0
    v_mov_b32 v55, 0
    v_mov_b32 v56, 0
    v_mov_b32 v57, 0
    v_mov_b32 v58, 0
    v_mov_b32 v59, 0
    v_mov_b32 v60, 0
    v_mov_b32 v61, 0
    v_mov_b32 v62, 0
    v_mov_b32 v63, 0
    s_add_u32 s72, s3, 1
    s_cmp_ge_u32 s85, s72
    s_cbranch_scc1 Lpe_8
Lp_7:
    ds_read_b32 v10, v1 offset:0
    s_waitcnt lgkmcnt(0)
    v_readfirstlane_b32 s85, v10
    s_nop 2
    s_cmp_ge_u32 s85, s72
    s_cbranch_scc1 Lpe_8
    s_sub_u32 s86, s86, 1
    s_cmp_gt_i32 s86, 0
    s_cbranch_scc1 Lp_7
Lpe_8:
    ds_read_b128 v[64:67], v20 offset:0
    ds_read_b128 v[68:71], v21 offset:0
    ds_read_b128 v[72:75], v22 offset:0
    ds_read_b128 v[76:79], v23 offset:0
    s_add_u32 s72, s3, 5
    s_cmp_ge_u32 s85, s72
    s_cbranch_scc1 Lpe_10
Lp_9:
    ds_read_b32 v10, v1 offset:0
    s_waitcnt lgkmcnt(0)
    v_readfirstlane_b32 s85, v10
    s_nop 2
    s_cmp_ge_u32 s85, s72
    s_cbranch_scc1 Lpe_10
    s_sub_u32 s86, s86, 1
    s_cmp_gt_i32 s86, 0
    s_cbranch_scc1 Lp_9
Lpe_10:
    ds_read_b128 v[80:83], v20 offset:16384
    ds_read_b128 v[84:87], v21 offset:16384
    ds_read_b128 v[88:91], v22 offset:16384
    ds_read_b128 v[92:95], v23 offset:16384
    s_add_u32 s72, s3, 9
    s_cmp_ge_u32 s85, s72
    s_cbranch_scc1 Lpe_12
Lp_11:
    ds_read_b32 v10, v1 offset:0
    s_waitcnt lgkmcnt(0)
    v_readfirstlane_b32 s85, v10
    s_nop 2
    s_cmp_ge_u32 s85, s72
    s_cbranch_scc1 Lpe_12
    s_sub_u32 s86, s86, 1
    s_cmp_gt_i32 s86, 0
    s_cbranch_scc1 Lp_11
Lpe_12:
    ds_read_b128 v[96:99], v20 offset:32768
    ds_read_b128 v[100:103], v21 offset:32768
    ds_read_b128 v[104:107], v22 offset:32768
    ds_read_b128 v[108:111], v23 offset:32768
Lf_13:
    ds_read_b64 v[10:11], v9 offset:256
    s_waitcnt lgkmcnt(0)
    v_min_u32 v10, v10, v11
    v_cmp_eq_u32 vcc, 0, v10
    s_cbranch_vccz Lfe_14
    s_sub_u32 s86, s86, 1
    s_cmp_gt_i32 s86, 0
    s_cbranch_scc1 Lf_13
Lfe_14:
    ds_read_b128 v[32:35], v8 offset:640
    ds_read_b128 v[36:39], v8 offset:704
    ds_read_b128 v[40:43], v8 offset:768
    ds_read_b128 v[44:47], v8 offset:832
    s_add_u32 s72, s3, 13
    s_cmp_ge_u32 s85, s72
    s_cbranch_scc1 Lpe_16
Lp_15:
    ds_read_b32 v10, v1 offset:0
    s_waitcnt lgkmcnt(0)
    v_readfirstlane_b32 s85, v10
    s_nop 2
    s_cmp_ge_u32 s85, s72
    s_cbranch_scc1 Lpe_16
    s_sub_u32 s86, s86, 1
    s_cmp_gt_i32 s86, 0
    s_cbranch_scc1 Lp_15
Lpe_16:
    ds_read_b128 v[112:115], v20 offset:49152
    ds_read_b128 v[116:119], v21 offset:49152
    ds_read_b128 v[120:123], v22 offset:49152
    ds_read_b128 v[124:127], v23 offset:49152
    s_waitcnt lgkmcnt(4)
    v_mfma_f32_16x16x32_bf16 v[48:51], v[64:67], v[32:35], v[48:51]
    v_mfma_f32_16x16x32_bf16 v[52:55], v[80:83], v[32:35], v[52:55]
    v_mfma_f32_16x16x32_bf16 v[56:59], v[96:99], v[32:35], v[56:59]
    v_mfma_f32_16x16x32_bf16 v[48:51], v[68:71], v[36:39], v[48:51]
    v_mfma_f32_16x16x32_bf16 v[52:55], v[84:87], v[36:39], v[52:55]
    v_mfma_f32_16x16x32_bf16 v[56:59], v[100:103], v[36:39], v[56:59]
    v_mfma_f32_16x16x32_bf16 v[48:51], v[72:75], v[40:43], v[48:51]
    v_mfma_f32_16x16x32_bf16 v[52:55], v[88:91], v[40:43], v[52:55]
    v_mfma_f32_16x16x32_bf16 v[56:59], v[104:107], v[40:43], v[56:59]
    v_mfma_f32_16x16x32_bf16 v[48:51], v[76:79], v[44:47], v[48:51]
    v_mfma_f32_16x16x32_bf16 v[52:55], v[92:95], v[44:47], v[52:55]
    v_mfma_f32_16x16x32_bf16 v[56:59], v[108:111], v[44:47], v[56:59]
    s_waitcnt lgkmcnt(0)
    v_mfma_f32_16x16x32_bf16 v[60:63], v[112:115], v[32:35], v[60:63]
    v_mfma_f32_16x16x32_bf16 v[60:63], v[116:119], v[36:39], v[60:63]
    v_mfma_f32_16x16x32_bf16 v[60:63], v[120:123], v[40:43], v[60:63]
    v_mfma_f32_16x16x32_bf16 v[60:63], v[124:127], v[44:47], v[60:63]
    s_mov_b32 s61, 0x3e0293ee
    v_max3_f32 v24, v48, v49, v50
    v_max3_f32 v25, v51, v52, v53
    v_max3_f32 v26, v54, v55, v56
    v_max3_f32 v27, v57, v58, v59
    v_max3_f32 v24, v24, v25, v26
    s_nop 1
    v_max3_f32 v28, v60, v61, v62
    v_max3_f32 v24, v24, v27, v63
    v_max_f32 v24, v24, v28
    v_mov_b32 v25, v24
    s_nop 1
    v_permlane16_swap_b32 v24, v25
    v_max_f32 v24, v24, v25
    v_mov_b32 v25, v24
    s_nop 1
    v_permlane32_swap_b32 v24, v25
    v_max_f32 v24, v24, v25
    v_or_b32 v24, 1, v24
    ds_write_b32 v5, v24 offset:320
Ls_17:
    ds_read_b128 v[24:27], v4 offset:320
    s_waitcnt lgkmcnt(0)
    v_min_u32 v28, v24, v25
    v_min3_u32 v28, v28, v26, v27
    v_cmp_eq_u32 vcc, 0, v28
    s_cbranch_vccz Lse_18
    s_sub_u32 s86, s86, 1
    s_cmp_gt_i32 s86, 0
    s_cbranch_scc1 Ls_17
Lse_18:
    v_max3_f32 v24, v24, v25, v26
    v_max_f32 v24, v24, v27
    v_mul_f32 v24, s61, v24
    v_fma_f32 v48, v48, s61, -v24
    v_fma_f32 v49, v49, s61, -v24
    v_fma_f32 v50, v50, s61, -v24
    v_fma_f32 v51, v51, s61, -v24
    v_fma_f32 v52, v52, s61, -v24
    v_fma_f32 v53, v53, s61, -v24
    v_fma_f32 v54, v54, s61, -v24
    v_fma_f32 v55, v55, s61, -v24
    v_fma_f32 v56, v56, s61, -v24
    v_fma_f32 v57, v57, s61, -v24
    v_fma_f32 v58, v58, s61, -v24
    v_fma_f32 v59, v59, s61, -v24
    v_fma_f32 v60, v60, s61, -v24
    v_fma_f32 v61, v61, s61, -v24
    v_fma_f32 v62, v62, s61, -v24
    v_fma_f32 v63, v63, s61, -v24
    v_exp_f32 v48, v48
    v_exp_f32 v49, v49
    v_exp_f32 v50, v50
    v_exp_f32 v51, v51
    v_exp_f32 v52, v52
    v_exp_f32 v53, v53
    v_exp_f32 v54, v54
    v_exp_f32 v55, v55
    v_exp_f32 v56, v56
    v_exp_f32 v57, v57
    v_exp_f32 v58, v58
    v_exp_f32 v59, v59
    v_exp_f32 v60, v60
    v_exp_f32 v61, v61
    v_exp_f32 v62, v62
    v_exp_f32 v63, v63
    v_cvt_pk_bf16_f32 v64, v48, v49
    v_cvt_pk_bf16_f32 v65, v50, v51
    v_cvt_pk_bf16_f32 v66, v52, v53
    v_cvt_pk_bf16_f32 v67, v54, v55
    v_cvt_pk_bf16_f32 v68, v56, v57
    v_cvt_pk_bf16_f32 v69, v58, v59
    v_cvt_pk_bf16_f32 v70, v60, v61
    v_cvt_pk_bf16_f32 v71, v62, v63
    v_and_b32 v6, 3, v0
    v_lshlrev_b32 v6, 6, v6
    v_lshl_add_u32 v6, v3, 4, v6
    s_lshr_b32 s72, s3, 1
    s_lshl_b32 s72, s72, 8
    s_and_b32 s73, s3, 1
    s_lshl_b32 s73, s73, 3
    s_add_u32 s72, s72, s73
    v_add_u32 v7, s72, v6
    ds_write_b64 v7, v[64:65] offset:1664
    ds_write_b64 v7, v[66:67] offset:2176
    ds_write_b64 v7, v[68:69] offset:2688
    ds_write_b64 v7, v[70:71] offset:3200
    v_add_f32 v25, v48, v49
    v_add_f32 v26, v50, v51
    v_add_f32 v27, v52, v53
    v_add_f32 v28, v54, v55
    v_add_f32 v29, v56, v57
    v_add_f32 v30, v58, v59
    v_add_f32 v31, v60, v61
    v_add_f32 v72, v62, v63
    v_add_f32 v25, v25, v26
    v_add_f32 v27, v27, v28
    v_add_f32 v29, v29, v30
    v_add_f32 v31, v31, v72
    v_add_f32 v25, v25, v27
    v_add_f32 v29, v29, v31
    v_add_f32 v25, v25, v29
    v_mov_b32 v26, v25
    s_nop 1
    v_permlane16_swap_b32 v25, v26
    v_add_f32 v25, v25, v26
    v_mov_b32 v26, v25
    s_nop 1
    v_permlane32_swap_b32 v25, v26
    v_add_f32 v25, v25, v26
    v_or_b32 v25, 1, v25
    ds_write_b32 v5, v25 offset:384
    v_bfe_u32 v8, v0, 2, 2
    v_and_b32 v9, 3, v0
    v_lshl_add_u32 v10, v3, 2, v8
    v_and_b32 v11, 7, v10
    v_lshlrev_b32 v10, 8, v10
    v_lshl_add_u32 v10, v9, 3, v10
    v_add_u32 v10, 94208, v10
    s_lshl_b32 s72, s3, 1
    v_xor_b32 v8, s72, v11
    v_lshl_add_u32 v20, v8, 5, v10
    s_add_u32 s72, s72, 1
    v_xor_b32 v8, s72, v11
    v_lshl_add_u32 v21, v8, 5, v10
    s_lshl_b32 s58, s48, 5
    s_add_u32 s58, s58, s49
    s_lshl_b32 s58, s58, 11
    s_lshl_b32 s59, s3, 7
    s_add_u32 s58, s58, s59
    s_add_u32 s58, s58, 1048576
    s_add_u32 s59, s58, 524288
    v_and_b32 v22, 3, v0
    v_lshlrev_b32 v22, 9, v22
    v_lshl_add_u32 v22, v3, 4, v22
    v_bfe_u32 v9, v0, 2, 1
    v_lshl_add_u32 v22, v9, 6, v22
    s_mov_b32 s54, 0x00f000f0
    s_mov_b32 s55, 0x00f000f0
    s_mov_b32 s56, 0x00ff00ff
    s_mov_b32 s57, 0x00ff00ff
Ls_19:
    ds_read_b128 v[28:31], v4 offset:384
    s_waitcnt lgkmcnt(0)
    v_min_u32 v27, v28, v29
    v_min3_u32 v27, v27, v30, v31
    v_cmp_eq_u32 vcc, 0, v27
    s_cbranch_vccz Lse_20
    s_sub_u32 s86, s86, 1
    s_cmp_gt_i32 s86, 0
    s_cbranch_scc1 Ls_19
Lse_20:
    ds_read_b128 v[32:35], v6 offset:1664
    ds_read_b128 v[36:39], v6 offset:1920
    ds_read_b128 v[40:43], v6 offset:2176
    ds_read_b128 v[44:47], v6 offset:2432
    ds_read_b128 v[48:51], v6 offset:2688
    ds_read_b128 v[52:55], v6 offset:2944
    ds_read_b128 v[56:59], v6 offset:3200
    ds_read_b128 v[60:63], v6 offset:3456
    v_add_f32 v28, v28, v29
    v_add_f32 v30, v30, v31
    v_add_f32 v25, v28, v30
    v_rcp_f32 v26, v25
    v_log_f32 v27, v25
    s_nop 0
    v_add_f32 v27, v27, v24
    v_xor_b32 v28, s84, v27
    v_mov_b32 v64, 0
    v_mov_b32 v65, 0
    v_mov_b32 v66, 0
    v_mov_b32 v67, 0
    v_mov_b32 v68, 0
    v_mov_b32 v69, 0
    v_mov_b32 v70, 0
    v_mov_b32 v71, 0
    s_cmp_ge_u32 s85, 18
    s_cbranch_scc1 Lpe_22
Lp_21:
    ds_read_b32 v10, v1 offset:0
    s_waitcnt lgkmcnt(0)
    v_readfirstlane_b32 s85, v10
    s_nop 2
    s_cmp_ge_u32 s85, 18
    s_cbranch_scc1 Lpe_22
    s_sub_u32 s86, s86, 1
    s_cmp_gt_i32 s86, 0
    s_cbranch_scc1 Lp_21
Lpe_22:
    ds_read_b64_tr_b16 v[72:73], v20 offset:0
    ds_read_b64_tr_b16 v[74:75], v20 offset:4096
    ds_read_b64_tr_b16 v[76:77], v21 offset:0
    ds_read_b64_tr_b16 v[78:79], v21 offset:4096
    s_cmp_ge_u32 s85, 20
    s_cbranch_scc1 Lpe_24
Lp_23:
    ds_read_b32 v10, v1 offset:0
    s_waitcnt lgkmcnt(0)
    v_readfirstlane_b32 s85, v10
    s_nop 2
    s_cmp_ge_u32 s85, 20
    s_cbranch_scc1 Lpe_24
    s_sub_u32 s86, s86, 1
    s_cmp_gt_i32 s86, 0
    s_cbranch_scc1 Lp_23
Lpe_24:
    ds_read_b64_tr_b16 v[80:81], v20 offset:8192
    ds_read_b64_tr_b16 v[82:83], v20 offset:12288
    ds_read_b64_tr_b16 v[84:85], v21 offset:8192
    ds_read_b64_tr_b16 v[86:87], v21 offset:12288
    s_waitcnt lgkmcnt(4)
    v_mfma_f32_16x16x32_bf16 v[64:67], v[72:75], v[32:35], v[64:67]
    v_mfma_f32_16x16x32_bf16 v[68:71], v[76:79], v[32:35], v[68:71]
    s_cmp_ge_u32 s85, 22
    s_cbranch_scc1 Lpe_26
Lp_25:
    ds_read_b32 v10, v1 offset:0
    s_waitcnt lgkmcnt(0)
    v_readfirstlane_b32 s85, v10
    s_nop 2
    s_cmp_ge_u32 s85, 22
    s_cbranch_scc1 Lpe_26
    s_sub_u32 s86, s86, 1
    s_cmp_gt_i32 s86, 0
    s_cbranch_scc1 Lp_25
Lpe_26:
    ds_read_b64_tr_b16 v[72:73], v20 offset:16384
    ds_read_b64_tr_b16 v[74:75], v20 offset:20480
    ds_read_b64_tr_b16 v[76:77], v21 offset:16384
    ds_read_b64_tr_b16 v[78:79], v21 offset:20480
    s_waitcnt lgkmcnt(4)
    v_mfma_f32_16x16x32_bf16 v[64:67], v[80:83], v[36:39], v[64:67]
    v_mfma_f32_16x16x32_bf16 v[68:71], v[84:87], v[36:39], v[68:71]
    s_cmp_ge_u32 s85, 24
    s_cbranch_scc1 Lpe_28
Lp_27:
    ds_read_b32 v10, v1 offset:0
    s_waitcnt lgkmcnt(0)
    v_readfirstlane_b32 s85, v10
    s_nop 2
    s_cmp_ge_u32 s85, 24
    s_cbranch_scc1 Lpe_28
    s_sub_u32 s86, s86, 1
    s_cmp_gt_i32 s86, 0
    s_cbranch_scc1 Lp_27
Lpe_28:
    ds_read_b64_tr_b16 v[80:81], v20 offset:24576
    ds_read_b64_tr_b16 v[82:83], v20 offset:28672
    ds_read_b64_tr_b16 v[84:85], v21 offset:24576
    ds_read_b64_tr_b16 v[86:87], v21 offset:28672
    s_waitcnt lgkmcnt(4)
    v_mfma_f32_16x16x32_bf16 v[64:67], v[72:75], v[40:43], v[64:67]
    v_mfma_f32_16x16x32_bf16 v[68:71], v[76:79], v[40:43], v[68:71]
    s_cmp_ge_u32 s85, 26
    s_cbranch_scc1 Lpe_30
Lp_29:
    ds_read_b32 v10, v1 offset:0
    s_waitcnt lgkmcnt(0)
    v_readfirstlane_b32 s85, v10
    s_nop 2
    s_cmp_ge_u32 s85, 26
    s_cbranch_scc1 Lpe_30
    s_sub_u32 s86, s86, 1
    s_cmp_gt_i32 s86, 0
    s_cbranch_scc1 Lp_29
Lpe_30:
    ds_read_b64_tr_b16 v[72:73], v20 offset:32768
    ds_read_b64_tr_b16 v[74:75], v20 offset:36864
    ds_read_b64_tr_b16 v[76:77], v21 offset:32768
    ds_read_b64_tr_b16 v[78:79], v21 offset:36864
    s_waitcnt lgkmcnt(4)
    v_mfma_f32_16x16x32_bf16 v[64:67], v[80:83], v[44:47], v[64:67]
    v_mfma_f32_16x16x32_bf16 v[68:71], v[84:87], v[44:47], v[68:71]
    s_cmp_ge_u32 s85, 28
    s_cbranch_scc1 Lpe_32
Lp_31:
    ds_read_b32 v10, v1 offset:0
    s_waitcnt lgkmcnt(0)
    v_readfirstlane_b32 s85, v10
    s_nop 2
    s_cmp_ge_u32 s85, 28
    s_cbranch_scc1 Lpe_32
    s_sub_u32 s86, s86, 1
    s_cmp_gt_i32 s86, 0
    s_cbranch_scc1 Lp_31
Lpe_32:
    ds_read_b64_tr_b16 v[80:81], v20 offset:40960
    ds_read_b64_tr_b16 v[82:83], v20 offset:45056
    ds_read_b64_tr_b16 v[84:85], v21 offset:40960
    ds_read_b64_tr_b16 v[86:87], v21 offset:45056
    s_waitcnt lgkmcnt(4)
    v_mfma_f32_16x16x32_bf16 v[64:67], v[72:75], v[48:51], v[64:67]
    v_mfma_f32_16x16x32_bf16 v[68:71], v[76:79], v[48:51], v[68:71]
    s_cmp_ge_u32 s85, 30
    s_cbranch_scc1 Lpe_34
Lp_33:
    ds_read_b32 v10, v1 offset:0
    s_waitcnt lgkmcnt(0)
    v_readfirstlane_b32 s85, v10
    s_nop 2
    s_cmp_ge_u32 s85, 30
    s_cbranch_scc1 Lpe_34
    s_sub_u32 s86, s86, 1
    s_cmp_gt_i32 s86, 0
    s_cbranch_scc1 Lp_33
Lpe_34:
    ds_read_b64_tr_b16 v[72:73], v20 offset:49152
    ds_read_b64_tr_b16 v[74:75], v20 offset:53248
    ds_read_b64_tr_b16 v[76:77], v21 offset:49152
    ds_read_b64_tr_b16 v[78:79], v21 offset:53248
    s_waitcnt lgkmcnt(4)
    v_mfma_f32_16x16x32_bf16 v[64:67], v[80:83], v[52:55], v[64:67]
    v_mfma_f32_16x16x32_bf16 v[68:71], v[84:87], v[52:55], v[68:71]
    s_cmp_ge_u32 s85, 32
    s_cbranch_scc1 Lpe_36
Lp_35:
    ds_read_b32 v10, v1 offset:0
    s_waitcnt lgkmcnt(0)
    v_readfirstlane_b32 s85, v10
    s_nop 2
    s_cmp_ge_u32 s85, 32
    s_cbranch_scc1 Lpe_36
    s_sub_u32 s86, s86, 1
    s_cmp_gt_i32 s86, 0
    s_cbranch_scc1 Lp_35
Lpe_36:
    ds_read_b64_tr_b16 v[80:81], v20 offset:57344
    ds_read_b64_tr_b16 v[82:83], v20 offset:61440
    ds_read_b64_tr_b16 v[84:85], v21 offset:57344
    ds_read_b64_tr_b16 v[86:87], v21 offset:61440
    s_waitcnt lgkmcnt(4)
    v_mfma_f32_16x16x32_bf16 v[64:67], v[72:75], v[56:59], v[64:67]
    v_mfma_f32_16x16x32_bf16 v[68:71], v[76:79], v[56:59], v[68:71]
    s_waitcnt lgkmcnt(0)
    v_mfma_f32_16x16x32_bf16 v[64:67], v[80:83], v[60:63], v[64:67]
    v_mfma_f32_16x16x32_bf16 v[68:71], v[84:87], v[60:63], v[68:71]
    s_nop 7
    v_cndmask_b32 v64, v64, v68, s[54:55]
    v_cndmask_b32 v65, v65, v69, s[54:55]
    v_cndmask_b32 v66, v66, v70, s[54:55]
    v_cndmask_b32 v67, v67, v71, s[54:55]
    v_mul_f32 v64, v64, v26
    v_mul_f32 v65, v65, v26
    v_mul_f32 v66, v66, v26
    v_mul_f32 v67, v67, v26
    v_cvt_pk_bf16_f32 v64, v64, v65
    v_cvt_pk_bf16_f32 v65, v66, v67
    v_mov_b32 v66, v27
    v_bitop3_b32 v67, v64, v65, v28 bitop3:0x96
    s_mov_b64 exec, s[56:57]
    buffer_store_dwordx4 v[64:67], v22, s[44:47], s58 offen
    buffer_store_dwordx4 v[64:67], v22, s[44:47], s59 offen sc1
    s_mov_b64 exec, -1
    s_lshr_b32 s52, s49, 3
    s_bfe_u32 s53, s49, 0x10002
    v_and_b32 v8, 7, v0
    v_bfe_u32 v9, v0, 3, 1
    v_lshl_add_u32 v8, v9, 4, v8
    v_lshlrev_b32 v8, 11, v8
    v_lshl_add_u32 v8, v3, 4, v8
    s_lshl_b32 s72, s48, 16
    s_lshl_b32 s73, s52, 9
    s_add_u32 s72, s72, s73
    s_lshl_b32 s73, s53, 8
    s_add_u32 s72, s72, s73
    s_lshl_b32 s73, s3, 6
    s_add_u32 s72, s72, s73
    s_add_u32 s72, s72, 1048576
    s_add_u32 s73, s72, 16384
    v_add_u32 v20, 0xfffea000, v20
    v_add_u32 v21, 0xfffea000, v21
    v_lshlrev_b32 v10, 5, v3
    v_lshl_add_u32 v10, v9, 4, v10
    s_lshr_b32 s74, s3, 1
    s_lshl_b32 s74, s74, 7
    s_and_b32 s75, s3, 1
    s_lshl_b32 s75, s75, 3
    s_add_u32 s74, s74, s75
    v_add_u32 v10, s74, v10
    v_and_b32 v11, 1, v0
    v_lshlrev_b32 v12, 2, v11
    v_lshlrev_b32 v11, 4, v11
    v_lshl_add_u32 v11, v3, 5, v11

    v_and_b32 v13, 1, v0
    v_lshlrev_b32 v13, 9, v13
    v_bfe_u32 v14, v0, 1, 1
    v_lshl_add_u32 v13, v14, 6, v13
    v_lshl_add_u32 v13, v3, 4, v13
    s_lshl_b32 s76, s51, 6
    s_add_u32 s76, s76, s50
    s_lshl_b32 s76, s76, 10
    s_lshl_b32 s77, s3, 7
    s_add_u32 s76, s76, s77
    s_add_u32 s76, s76, 458752
    s_mov_b32 s54, 0xcccccccc
    s_mov_b32 s55, 0xcccccccc
    s_mov_b32 s56, 0x000f000f
    s_mov_b32 s57, 0x000f000f
    s_mov_b32 s78, 0x01010101
    s_mov_b32 s79, 0x01010101
    v_mov_b32 v96, 0
    v_mov_b32 v97, 0
    v_mov_b32 v98, 0
    v_mov_b32 v99, 0
    v_mov_b32 v100, 0
    v_mov_b32 v101, 0
    v_mov_b32 v102, 0
    v_mov_b32 v103, 0
    v_mov_b32 v104, 0
    v_mov_b32 v105, 0
    v_mov_b32 v106, 0
    v_mov_b32 v107, 0
    v_mov_b32 v108, 0
    v_mov_b32 v109, 0
    v_mov_b32 v110, 0
    v_mov_b32 v111, 0
    s_mov_b32 s101, 16384
Lg_37:
    s_sub_u32 s100, 16376, s101
    s_cmp_ge_i32 s100, 0
    s_cselect_b32 s100, s101, 0
    s_and_b32 s100, s100, 1
    s_mul_i32 s100, s100, 524288
    s_add_u32 s60, s72, s100
    s_add_u32 s61, s73, s100
    buffer_load_dwordx4 v[32:35], v8, s[44:47], s60 offen sc1
    buffer_load_dwordx4 v[36:39], v8, s[44:47], s61 offen sc1
    s_waitcnt vmcnt(0)
    v_bitop3_b32 v48, v32, v33, v34 bitop3:0x96
    v_bitop3_b32 v48, v48, v35, s84 bitop3:0x96
    v_bitop3_b32 v49, v36, v37, v38 bitop3:0x96
    v_bitop3_b32 v49, v49, v39, s84 bitop3:0x96
    v_or_b32 v48, v48, v49
    v_cmp_ne_u32 vcc, 0, v48
    s_cbranch_vccz Lge_38
    s_sleep 1
    s_sub_u32 s101, s101, 1
    s_cmp_gt_i32 s101, 0
    s_cbranch_scc1 Lg_37
Lge_38:
    v_max_f32 v48, v34, v38
    v_lshlrev_b32 v50, 16, v32
    v_and_b32 v51, 0xffff0000, v32
    v_max_f32_dpp v48, v48, v48 quad_perm:[1,0,3,2] row_mask:0xf bank_mask:0xf
    v_lshlrev_b32 v52, 16, v33
    v_and_b32 v53, 0xffff0000, v33
    v_max_f32_dpp v48, v48, v48 quad_perm:[2,3,0,1] row_mask:0xf bank_mask:0xf
    v_lshlrev_b32 v54, 16, v36
    v_and_b32 v55, 0xffff0000, v36
    v_max_f32_dpp v48, v48, v48 row_half_mirror row_mask:0xf bank_mask:0xf
    v_lshlrev_b32 v56, 16, v37
    v_and_b32 v57, 0xffff0000, v37
    v_sub_f32 v40, v34, v48
    v_sub_f32 v44, v38, v48
    v_exp_f32 v40, v40
    v_exp_f32 v44, v44
    v_mul_f32 v32, v40, v50
    v_mul_f32 v33, v40, v51
    v_mul_f32 v34, v40, v52
    v_mul_f32 v35, v40, v53
    v_add_f32 v49, v40, v44
    v_fmac_f32 v32, v44, v54
    v_fmac_f32 v33, v44, v55
    v_fmac_f32 v34, v44, v56
    v_fmac_f32 v35, v44, v57
    v_add_f32_dpp v49, v49, v49 quad_perm:[1,0,3,2] row_mask:0xf bank_mask:0xf
    v_add_f32_dpp v32, v32, v32 quad_perm:[1,0,3,2] row_mask:0xf bank_mask:0xf
    v_add_f32_dpp v33, v33, v33 quad_perm:[1,0,3,2] row_mask:0xf bank_mask:0xf
    v_add_f32_dpp v34, v34, v34 quad_perm:[1,0,3,2] row_mask:0xf bank_mask:0xf
    v_add_f32_dpp v35, v35, v35 quad_perm:[1,0,3,2] row_mask:0xf bank_mask:0xf
    v_add_f32_dpp v49, v49, v49 quad_perm:[2,3,0,1] row_mask:0xf bank_mask:0xf
    v_add_f32_dpp v32, v32, v32 quad_perm:[2,3,0,1] row_mask:0xf bank_mask:0xf
    v_add_f32_dpp v33, v33, v33 quad_perm:[2,3,0,1] row_mask:0xf bank_mask:0xf
    v_add_f32_dpp v34, v34, v34 quad_perm:[2,3,0,1] row_mask:0xf bank_mask:0xf
    v_add_f32_dpp v35, v35, v35 quad_perm:[2,3,0,1] row_mask:0xf bank_mask:0xf
    v_add_f32_dpp v49, v49, v49 row_half_mirror row_mask:0xf bank_mask:0xf
    v_add_f32_dpp v32, v32, v32 row_half_mirror row_mask:0xf bank_mask:0xf
    v_add_f32_dpp v33, v33, v33 row_half_mirror row_mask:0xf bank_mask:0xf
    v_add_f32_dpp v34, v34, v34 row_half_mirror row_mask:0xf bank_mask:0xf
    v_add_f32_dpp v35, v35, v35 row_half_mirror row_mask:0xf bank_mask:0xf
    v_rcp_f32 v49, v49
    s_nop 0
    v_mul_f32 v32, v32, v49
    v_mul_f32 v33, v33, v49
    v_mul_f32 v34, v34, v49
    v_mul_f32 v35, v35, v49
    v_cvt_pk_bf16_f32 v32, v32, v33
    v_cvt_pk_bf16_f32 v33, v34, v35
    s_mov_b64 exec, s[78:79]
    ds_write_b64 v10, v[32:33] offset:3712
    s_mov_b64 exec, -1
    s_waitcnt lgkmcnt(0)
    s_barrier
    ds_read_b128 v[32:35], v11 offset:3712
    ds_read_b128 v[36:39], v11 offset:3840
    ds_read_b64_tr_b16 v[64:65], v20 offset:0
    ds_read_b64_tr_b16 v[66:67], v20 offset:4096
    ds_read_b64_tr_b16 v[68:69], v21 offset:0
    ds_read_b64_tr_b16 v[70:71], v21 offset:4096
    ds_read_b64_tr_b16 v[72:73], v20 offset:8192
    ds_read_b64_tr_b16 v[74:75], v20 offset:12288
    ds_read_b64_tr_b16 v[76:77], v21 offset:8192
    ds_read_b64_tr_b16 v[78:79], v21 offset:12288
    ds_read_b128 v[40:43], v11 offset:448
    ds_read_b64_tr_b16 v[80:81], v20 offset:16384
    ds_read_b64_tr_b16 v[82:83], v20 offset:20480
    ds_read_b64_tr_b16 v[84:85], v21 offset:16384
    ds_read_b64_tr_b16 v[86:87], v21 offset:20480
    s_waitcnt lgkmcnt(11)
    v_mfma_f32_16x16x32_bf16 v[96:99], v[64:67], v[32:35], v[96:99]
    ds_read_b32 v30, v12 offset:288
    s_waitcnt lgkmcnt(10)
    v_mfma_f32_16x16x32_bf16 v[100:103], v[68:71], v[32:35], v[100:103]
    s_waitcnt lgkmcnt(8)
    v_mfma_f32_16x16x32_bf16 v[96:99], v[72:75], v[36:39], v[96:99]
    s_waitcnt lgkmcnt(6)
    v_mfma_f32_16x16x32_bf16 v[100:103], v[76:79], v[36:39], v[100:103]
    s_waitcnt lgkmcnt(3)
    v_mfma_f32_16x16x32_bf16 v[104:107], v[80:83], v[40:43], v[104:107]
    s_waitcnt lgkmcnt(1)
    v_mfma_f32_16x16x32_bf16 v[108:111], v[84:87], v[40:43], v[108:111]
    s_waitcnt lgkmcnt(0)
    v_sub_f32 v31, 1.0, v30
    s_nop 1
    v_cndmask_b32 v96, v96, v100, s[54:55]
    v_cndmask_b32 v97, v97, v101, s[54:55]
    v_cndmask_b32 v98, v98, v102, s[54:55]
    v_cndmask_b32 v99, v99, v103, s[54:55]
    v_mul_f32 v96, v96, v30
    v_mul_f32 v97, v97, v30
    v_mul_f32 v98, v98, v30
    v_mul_f32 v99, v99, v30
    v_cndmask_b32 v104, v104, v108, s[54:55]
    v_cndmask_b32 v105, v105, v109, s[54:55]
    v_cndmask_b32 v106, v106, v110, s[54:55]
    v_cndmask_b32 v107, v107, v111, s[54:55]
    v_fmac_f32 v96, v104, v31
    v_fmac_f32 v97, v105, v31
    v_fmac_f32 v98, v106, v31
    v_fmac_f32 v99, v107, v31
    v_bfi_b32 v96, s87, v16, v96
    v_bfi_b32 v97, s87, v17, v97
    v_bfi_b32 v98, s87, v18, v98
    v_bfi_b32 v99, s87, v19, v99
    s_mov_b64 exec, s[56:57]
    buffer_store_dwordx4 v[96:99], v13, s[44:47], s76 offen sc1

    s_mov_b64 exec, -1
    s_cmp_ge_u32 s3, 1
    s_cbranch_scc1 L_stampout
    s_lshr_b32 s66, s49, 3
    s_lshl_b32 s66, s66, 3
    s_add_u32 s66, s66, s48
    s_lshl_b32 s66, s66, 3
    s_and_b32 s67, s49, 7
    s_add_u32 s66, s66, s67

    s_bfe_u32 s72, s66, 0x20005
    s_lshl_b32 s72, s72, 16
    s_lshr_b32 s73, s66, 7
    s_lshl_b32 s73, s73, 9
    s_add_u32 s72, s72, s73
    s_and_b32 s73, s66, 31
    s_lshl_b32 s73, s73, 4
    s_add_u32 s72, s72, s73
    s_add_u32 s72, s72, 458752
    v_lshlrev_b32 v6, 10, v0
    s_lshl_b32 s74, s48, 9
        s_add_u32 s74, s74, 720896
        s_lshl_b32 s75, s49, 4
        s_add_u32 s75, s75, s74
        v_mov_b32 v40, s84
        v_mov_b32 v41, 0
        v_and_b32 v42, 31, v0
        v_lshlrev_b32 v42, 4, v42
        s_mov_b64 exec, 1
        buffer_store_dword v40, v41, s[44:47], s75 offen
        s_mov_b64 exec, -1
        s_mov_b32 s101, 10
    Llf_39:
        buffer_load_dword v43, v42, s[44:47], s74 offen sc1
        s_waitcnt vmcnt(0)
        v_cmp_ne_u32 vcc, s84, v43
        s_cbranch_vccz Llfe_40
        s_sub_u32 s101, s101, 1
        s_cmp_gt_i32 s101, 0
        s_cbranch_scc1 Llf_39
    Llfe_40:
    s_mov_b32 s101, 16384
Lg_41:
    buffer_load_dwordx4 v[32:35], v6, s[44:47], s72 offen sc1
    s_waitcnt vmcnt(0)
    v_xor_b32 v32, s80, v32
    v_xor_b32 v33, s81, v33
    v_xor_b32 v34, s82, v34
    v_xor_b32 v35, s83, v35
    v_or3_b32 v48, v32, v33, v34
    v_or_b32 v48, v48, v35
    v_and_b32 v48, 0xff, v48
    v_cmp_ne_u32 vcc, 0, v48
    s_cbranch_vccz Lge_42
    s_sleep 1
    s_sub_u32 s101, s101, 1
    s_cmp_gt_i32 s101, 0
    s_cbranch_scc1 Lg_41
Lge_42:
    v_permlane32_swap_b32 v32, v34
    v_permlane32_swap_b32 v33, v35
    v_add_f32 v32, v32, v34
    v_add_f32 v33, v33, v35
    s_nop 1
    v_permlane16_swap_b32 v32, v33
    v_add_f32 v32, v32, v33
    s_nop 1
    v_add_f32_dpp v32, v32, v32 row_ror:8 row_mask:0xf bank_mask:0xf
    s_nop 1
    v_add_f32_dpp v32, v32, v32 row_ror:4 row_mask:0xf bank_mask:0xf
    s_nop 1
    v_add_f32_dpp v32, v32, v32 row_ror:2 row_mask:0xf bank_mask:0xf
    s_nop 1
    v_add_f32_dpp v32, v32, v32 row_ror:1 row_mask:0xf bank_mask:0xf
    v_cvt_pk_bf16_f32 v32, v32, v32
    v_lshlrev_b32 v6, 1, v3
    s_lshl_b32 s72, s66, 3
    v_cmp_eq_u32 vcc, 0, v2
    s_nop 2
    s_and_saveexec_b64 s[70:71], vcc
    buffer_store_short v32, v6, s[40:43], s72 offen
    s_cmp_eq_u32 s2, 0
    s_cbranch_scc0 L_noep
    s_mov_b64 exec, 1
    v_mov_b32 v7, s84
    v_mov_b32 v8, 0
    buffer_store_dword v7, v8, s[44:47], 0 offen
L_noep:
    s_mov_b64 exec, s[70:71]
L_stampout:
    s_endpgm

L_others:
    s_cmp_eq_u32 s3, 4
    s_cbranch_scc1 L_helper
    s_mov_b32 s46, 0x20000000
    s_mov_b32 s47, 0x20000
    s_mov_b32 s42, 0x800
    s_mov_b32 s43, 0x20000
    v_and_b32 v2, 15, v0
    v_lshrrev_b32 v3, 4, v0
    v_lshlrev_b32 v1, 2, v0
    s_lshr_b32 s50, s49, 2
    s_lshl_b32 s51, s48, 3
    s_add_u32 s50, s50, s51
    s_and_b32 s51, s49, 3
    s_mov_b32 s85, 0
    s_mov_b32 s86, 1048576
    s_mov_b32 s87, 0xff
    v_lshlrev_b32 v11, 4, v0
    s_waitcnt lgkmcnt(0)
    s_load_dword s84, s[44:45], 0x0
    s_barrier
    v_and_b32 v4, 1, v0
    v_bfe_u32 v5, v0, 1, 2
    v_mov_b32 v6, 0x0c0c0100
    v_mov_b32 v8, 0x01000c0c
    v_cmp_eq_u32 vcc, 1, v4
    s_nop 1
    v_cndmask_b32 v6, v6, v8, vcc
    v_mov_b32 v8, 0x0c0c0302
    v_mov_b32 v10, 0x03020c0c
    v_cndmask_b32 v8, v8, v10, vcc
    v_mov_b32 v10, 0x0c0c0c0c
    v_cmp_eq_u32 vcc, 0, v5
    s_nop 1
    v_cndmask_b32 v136, v10, v6, vcc
    v_cndmask_b32 v137, v10, v8, vcc
    v_cmp_eq_u32 vcc, 1, v5
    s_nop 1
    v_cndmask_b32 v138, v10, v6, vcc
    v_cndmask_b32 v139, v10, v8, vcc
    v_cmp_eq_u32 vcc, 2, v5
    s_nop 1
    v_cndmask_b32 v140, v10, v6, vcc
    v_cndmask_b32 v141, v10, v8, vcc
    v_cmp_eq_u32 vcc, 3, v5
    s_nop 1
    v_cndmask_b32 v142, v10, v6, vcc
    v_cndmask_b32 v143, v10, v8, vcc
    s_waitcnt lgkmcnt(0)
    s_add_u32 s84, s84, 0x01010101
    s_and_b32 s80, s84, 0xff
    s_bfe_u32 s81, s84, 0x80008
    s_bfe_u32 s82, s84, 0x80010
    s_lshr_b32 s83, s84, 24
    v_mov_b32 v16, s80
    v_mov_b32 v17, s81
    v_mov_b32 v18, s82
    v_mov_b32 v19, s83
    s_cmp_eq_u32 s3, 3
    s_cbranch_scc1 L_qwait
    s_lshr_b32 s72, s49, 4
    s_lshl_b32 s73, s72, 14
    s_lshl_b32 s74, s48, 11
    s_add_u32 s73, s73, s74
    s_and_b32 s74, s3, 1
    s_lshl_b32 s74, s74, 10
    s_add_u32 s73, s73, s74
    s_add_u32 s73, s73, 65536
    s_add_u32 s74, s73, 32768
    s_add_u32 s75, s73, 65536
    s_add_u32 s76, s73, 98304
    v_mov_b32 v9, 0
Lf_1:
    ds_read_b32 v10, v9 offset:284
    s_waitcnt lgkmcnt(0)
    v_cmp_eq_u32 vcc, 0, v10
    s_cbranch_vccz Lfe_2
    s_sub_u32 s86, s86, 1
    s_cmp_gt_i32 s86, 0
    s_cbranch_scc1 Lf_1
Lfe_2:
    ds_read_b32 v10, v1 offset:0
    s_waitcnt lgkmcnt(0)
    v_readfirstlane_b32 s72, v10
    s_nop 2
    s_add_u32 s72, s72, 3
    s_min_u32 s72, s72, 16
    s_cmp_ge_u32 s85, s72
    s_cbranch_scc1 Lpe_4
Lp_3:
    ds_read_b32 v10, v1 offset:0
    s_waitcnt lgkmcnt(0)
    v_readfirstlane_b32 s85, v10
    s_nop 2
    s_cmp_ge_u32 s85, s72
    s_cbranch_scc1 Lpe_4
    s_sub_u32 s86, s86, 1
    s_cmp_gt_i32 s86, 0
    s_cbranch_scc1 Lp_3
Lpe_4:
    s_mov_b32 s101, 16384
Lg_5:
    s_sub_u32 s100, 16380, s101
    s_cmp_ge_i32 s100, 0
    s_cselect_b32 s100, s101, 0
    s_and_b32 s100, s100, 1
    s_mul_i32 s100, s100, 131072
    s_add_u32 s60, s73, s100
    s_add_u32 s61, s74, s100
    s_add_u32 s62, s75, s100
    s_add_u32 s63, s76, s100
    buffer_load_dwordx4 v[32:35], v11, s[44:47], s60 offen sc1
    buffer_load_dwordx4 v[36:39], v11, s[44:47], s61 offen sc1
    buffer_load_dwordx4 v[40:43], v11, s[44:47], s62 offen sc1
    buffer_load_dwordx4 v[44:47], v11, s[44:47], s63 offen sc1
    s_waitcnt vmcnt(0)
    v_xor_b32 v32, s80, v32
    v_xor_b32 v33, s81, v33
    v_xor_b32 v34, s82, v34
    v_xor_b32 v35, s83, v35
    v_xor_b32 v36, s80, v36
    v_xor_b32 v37, s81, v37
    v_xor_b32 v38, s82, v38
    v_xor_b32 v39, s83, v39
    v_xor_b32 v40, s80, v40
    v_xor_b32 v41, s81, v41
    v_xor_b32 v42, s82, v42
    v_xor_b32 v43, s83, v43
    v_xor_b32 v44, s80, v44
    v_xor_b32 v45, s81, v45
    v_xor_b32 v46, s82, v46
    v_xor_b32 v47, s83, v47
    v_or3_b32 v48, v32, v33, v34
    v_or_b32 v48, v48, v35
    v_or3_b32 v48, v48, v36, v37
    v_or3_b32 v48, v48, v38, v39
    v_or3_b32 v48, v48, v40, v41
    v_or3_b32 v48, v48, v42, v43
    v_or3_b32 v48, v48, v44, v45
    v_or3_b32 v48, v48, v46, v47
    v_and_b32 v48, 0xff, v48
    v_cmp_ne_u32 vcc, 0, v48
    s_cbranch_vccz Lge_6
    s_sub_u32 s101, s101, 1
    s_cmp_gt_i32 s101, 0
    s_cbranch_scc1 Lg_5
Lge_6:
    v_add_f32 v32, v32, v36
    v_add_f32 v40, v40, v44
    v_add_f32 v33, v33, v37
    v_add_f32 v41, v41, v45
    v_add_f32 v34, v34, v38
    v_add_f32 v42, v42, v46
    v_add_f32 v35, v35, v39
    v_add_f32 v43, v43, v47
    v_add_f32 v32, v32, v40
    v_add_f32 v33, v33, v41
    v_add_f32 v34, v34, v42
    v_add_f32 v35, v35, v43
    v_cvt_pk_bf16_f32 v32, v32, v33
    v_cvt_pk_bf16_f32 v33, v34, v35
    v_lshlrev_b32 v4, 3, v0
    s_and_b32 s72, s3, 1
    s_lshl_b32 s73, s72, 9
    v_add_u32 v4, s73, v4
    ds_write_b64 v4, v[32:33] offset:640
    v_mov_b32 v5, 1
    s_lshl_b32 s72, s72, 2
    v_mov_b32 v4, s72
    ds_write_b32 v4, v5 offset:256
    s_branch L_qwait

L_helper:
    s_load_dwordx2 s[36:37], s[0:1], 64
    s_load_dwordx2 s[28:29], s[0:1], 48
    s_mov_b32 s10, 0x800
    s_mov_b32 s11, 0x20000
    s_mov_b32 s38, 0x400
    s_mov_b32 s39, 0x20000
    s_mov_b32 s30, 0x1c0000
    s_mov_b32 s31, 0x20000
    s_mov_b32 s46, 0x20000000
    s_mov_b32 s47, 0x20000
    v_and_b32 v2, 15, v0
    v_lshrrev_b32 v3, 4, v0
    v_lshlrev_b32 v1, 2, v0
    s_lshr_b32 s50, s49, 2
    s_lshl_b32 s51, s48, 3
    s_add_u32 s50, s50, s51
    s_and_b32 s51, s49, 3
    s_mov_b32 s85, 0
    s_mov_b32 s86, 1048576
    s_mov_b32 s87, 0xff
    s_mul_i32 s59, s2, 2341
    s_lshr_b32 s59, s59, 16
    s_mul_i32 s60, s59, 28
    s_sub_u32 s60, s2, s60
    s_lshl_b32 s61, s59, 6
    s_mul_i32 s62, s61, 3584
    s_lshl_b32 s63, s60, 7
    s_add_u32 s62, s62, s63
    v_lshrrev_b32 v5, 3, v0
    v_and_b32 v6, 7, v0
    v_lshlrev_b32 v6, 4, v6
    v_mul_u32_u24 v7, 28672, v5
    v_add_u32 v7, v7, v6
    v_lshlrev_b32 v9, 4, v5
    s_lshl_b32 s64, s61, 1
    v_lshlrev_b32 v11, 4, v0

    s_waitcnt lgkmcnt(0)
    s_load_dword s84, s[44:45], 0x0
    s_barrier
    buffer_load_dwordx4 v[112:115], v11, s[8:11], 0 offen
    buffer_load_dwordx4 v[116:119], v11, s[8:11], 0 offen offset:1024
    buffer_load_dwordx4 v[120:123], v11, s[36:39], 0 offen
    buffer_load_dwordx4 v[20:23], v9, s[8:11], s64 offen
    buffer_load_dwordx4 v[28:31], v9, s[8:11], s64 offen offset:1024
    buffer_load_dwordx4 v[64:67], v7, s[28:31], s62 offen nt
    s_add_u32 s62, s62, 3584
    buffer_load_dwordx4 v[68:71], v7, s[28:31], s62 offen nt
    s_add_u32 s62, s62, 3584
    buffer_load_dwordx4 v[72:75], v7, s[28:31], s62 offen nt
    s_add_u32 s62, s62, 3584
    buffer_load_dwordx4 v[76:79], v7, s[28:31], s62 offen nt
    s_add_u32 s62, s62, 3584
    buffer_load_dwordx4 v[80:83], v7, s[28:31], s62 offen nt
    s_add_u32 s62, s62, 3584
    buffer_load_dwordx4 v[84:87], v7, s[28:31], s62 offen nt
    s_add_u32 s62, s62, 3584
    buffer_load_dwordx4 v[88:91], v7, s[28:31], s62 offen nt
    s_add_u32 s62, s62, 3584
    buffer_load_dwordx4 v[92:95], v7, s[28:31], s62 offen nt
    v_and_b32 v4, 1, v0
    v_bfe_u32 v5, v0, 1, 2
    v_mov_b32 v6, 0x0c0c0100
    v_mov_b32 v8, 0x01000c0c
    v_cmp_eq_u32 vcc, 1, v4
    s_nop 1
    v_cndmask_b32 v6, v6, v8, vcc
    v_mov_b32 v8, 0x0c0c0302
    v_mov_b32 v10, 0x03020c0c
    v_cndmask_b32 v8, v8, v10, vcc
    v_mov_b32 v10, 0x0c0c0c0c
    v_cmp_eq_u32 vcc, 0, v5
    s_nop 1
    v_cndmask_b32 v136, v10, v6, vcc
    v_cndmask_b32 v137, v10, v8, vcc
    v_cmp_eq_u32 vcc, 1, v5
    s_nop 1
    v_cndmask_b32 v138, v10, v6, vcc
    v_cndmask_b32 v139, v10, v8, vcc
    v_cmp_eq_u32 vcc, 2, v5
    s_nop 1
    v_cndmask_b32 v140, v10, v6, vcc
    v_cndmask_b32 v141, v10, v8, vcc
    v_cmp_eq_u32 vcc, 3, v5
    s_nop 1
    v_cndmask_b32 v142, v10, v6, vcc
    v_cndmask_b32 v143, v10, v8, vcc
    s_waitcnt lgkmcnt(0)
    s_add_u32 s84, s84, 0x01010101
    s_and_b32 s80, s84, 0xff
    s_bfe_u32 s81, s84, 0x80008
    s_bfe_u32 s82, s84, 0x80010
    s_lshr_b32 s83, s84, 24
    v_mov_b32 v16, s80
    v_mov_b32 v17, s81
    v_mov_b32 v18, s82
    v_mov_b32 v19, s83
    s_mul_i32 s72, s59, 14336
    s_lshl_b32 s73, s60, 8
    s_add_u32 s72, s72, s73
    s_add_u32 s72, s72, 327680
    v_lshrrev_b32 v4, 5, v0
    v_mul_u32_u24 v4, 7168, v4
    v_and_b32 v5, 7, v0
    v_lshl_add_u32 v4, v5, 5, v4
    v_bfe_u32 v5, v0, 4, 1
    v_lshl_add_u32 v4, v5, 4, v4
    s_mov_b32 s70, 0x00ff00ff
    s_mov_b32 s71, 0x00ff00ff
    v_mov_b32 v128, 0
    v_mov_b32 v129, 0
    v_mov_b32 v130, 0
    v_mov_b32 v131, 0
    v_mov_b32 v132, 0
    v_mov_b32 v133, 0
    v_mov_b32 v134, 0
    v_mov_b32 v135, 0
    s_waitcnt vmcnt(8)
    v_perm_b32 v48, v20, v20, v136
    v_perm_b32 v49, v20, v20, v138
    v_perm_b32 v50, v20, v20, v140
    v_perm_b32 v51, v20, v20, v142
    v_perm_b32 v52, v28, v28, v136
    v_perm_b32 v53, v28, v28, v138
    v_perm_b32 v54, v28, v28, v140
    v_perm_b32 v55, v28, v28, v142
    v_perm_b32 v56, v20, v20, v137
    v_perm_b32 v57, v20, v20, v139
    v_perm_b32 v58, v20, v20, v141
    v_perm_b32 v59, v20, v20, v143
    v_perm_b32 v60, v28, v28, v137
    v_perm_b32 v61, v28, v28, v139
    v_perm_b32 v62, v28, v28, v141
    v_perm_b32 v63, v28, v28, v143
    s_waitcnt vmcnt(7)
    v_mfma_f32_16x16x32_bf16 v[128:131], v[48:51], v[64:67], v[128:131]
    v_mfma_f32_16x16x32_bf16 v[132:135], v[52:55], v[64:67], v[132:135]
    v_perm_b32 v48, v21, v21, v136
    v_perm_b32 v49, v21, v21, v138
    v_perm_b32 v50, v21, v21, v140
    v_perm_b32 v51, v21, v21, v142
    v_perm_b32 v52, v29, v29, v136
    v_perm_b32 v53, v29, v29, v138
    v_perm_b32 v54, v29, v29, v140
    v_perm_b32 v55, v29, v29, v142
    s_waitcnt vmcnt(6)
    v_mfma_f32_16x16x32_bf16 v[128:131], v[56:59], v[68:71], v[128:131]
    v_mfma_f32_16x16x32_bf16 v[132:135], v[60:63], v[68:71], v[132:135]
    v_perm_b32 v56, v21, v21, v137
    v_perm_b32 v57, v21, v21, v139
    v_perm_b32 v58, v21, v21, v141
    v_perm_b32 v59, v21, v21, v143
    v_perm_b32 v60, v29, v29, v137
    v_perm_b32 v61, v29, v29, v139
    v_perm_b32 v62, v29, v29, v141
    v_perm_b32 v63, v29, v29, v143
    s_waitcnt vmcnt(5)
    v_mfma_f32_16x16x32_bf16 v[128:131], v[48:51], v[72:75], v[128:131]
    v_mfma_f32_16x16x32_bf16 v[132:135], v[52:55], v[72:75], v[132:135]
    v_perm_b32 v48, v22, v22, v136
    v_perm_b32 v49, v22, v22, v138
    v_perm_b32 v50, v22, v22, v140
    v_perm_b32 v51, v22, v22, v142
    v_perm_b32 v52, v30, v30, v136
    v_perm_b32 v53, v30, v30, v138
    v_perm_b32 v54, v30, v30, v140
    v_perm_b32 v55, v30, v30, v142
    s_waitcnt vmcnt(4)
    v_mfma_f32_16x16x32_bf16 v[128:131], v[56:59], v[76:79], v[128:131]
    v_mfma_f32_16x16x32_bf16 v[132:135], v[60:63], v[76:79], v[132:135]
    v_perm_b32 v56, v22, v22, v137
    v_perm_b32 v57, v22, v22, v139
    v_perm_b32 v58, v22, v22, v141
    v_perm_b32 v59, v22, v22, v143
    v_perm_b32 v60, v30, v30, v137
    v_perm_b32 v61, v30, v30, v139
    v_perm_b32 v62, v30, v30, v141
    v_perm_b32 v63, v30, v30, v143
    s_waitcnt vmcnt(3)
    v_mfma_f32_16x16x32_bf16 v[128:131], v[48:51], v[80:83], v[128:131]
    v_mfma_f32_16x16x32_bf16 v[132:135], v[52:55], v[80:83], v[132:135]
    v_perm_b32 v48, v23, v23, v136
    v_perm_b32 v49, v23, v23, v138
    v_perm_b32 v50, v23, v23, v140
    v_perm_b32 v51, v23, v23, v142
    v_perm_b32 v52, v31, v31, v136
    v_perm_b32 v53, v31, v31, v138
    v_perm_b32 v54, v31, v31, v140
    v_perm_b32 v55, v31, v31, v142
    s_waitcnt vmcnt(2)
    v_mfma_f32_16x16x32_bf16 v[128:131], v[56:59], v[84:87], v[128:131]
    v_mfma_f32_16x16x32_bf16 v[132:135], v[60:63], v[84:87], v[132:135]
    v_perm_b32 v56, v23, v23, v137
    v_perm_b32 v57, v23, v23, v139
    v_perm_b32 v58, v23, v23, v141
    v_perm_b32 v59, v23, v23, v143
    v_perm_b32 v60, v31, v31, v137
    v_perm_b32 v61, v31, v31, v139
    v_perm_b32 v62, v31, v31, v141
    v_perm_b32 v63, v31, v31, v143
    s_waitcnt vmcnt(1)
    v_mfma_f32_16x16x32_bf16 v[128:131], v[48:51], v[88:91], v[128:131]
    v_mfma_f32_16x16x32_bf16 v[132:135], v[52:55], v[88:91], v[132:135]
    s_waitcnt vmcnt(0)
    v_mfma_f32_16x16x32_bf16 v[128:131], v[56:59], v[92:95], v[128:131]
    v_mfma_f32_16x16x32_bf16 v[132:135], v[60:63], v[92:95], v[132:135]
    s_nop 7
    v_permlane32_swap_b32 v128, v132
    v_permlane32_swap_b32 v129, v133
    v_permlane32_swap_b32 v130, v134
    v_permlane32_swap_b32 v131, v135
    v_add_f32_dpp v36, v132, v128 row_ror:8 row_mask:0xf bank_mask:0xf
    v_add_f32_dpp v37, v133, v129 row_ror:8 row_mask:0xf bank_mask:0xf
    v_add_f32_dpp v38, v134, v130 row_ror:8 row_mask:0xf bank_mask:0xf
    v_add_f32_dpp v39, v135, v131 row_ror:8 row_mask:0xf bank_mask:0xf
    v_bfi_b32 v36, s87, v16, v36
    v_bfi_b32 v37, s87, v17, v37
    v_bfi_b32 v38, s87, v18, v38
    v_bfi_b32 v39, s87, v19, v39
    s_cmp_ge_u32 s2, 224
    s_cbranch_scc1 L_nohpub
    s_mov_b64 exec, s[70:71]
    buffer_store_dwordx4 v[36:39], v4, s[44:47], s72 offen sc1
    s_mov_b64 exec, -1
L_nohpub:
    v_mov_b32 v44, 0
    v_lshlrev_b32 v46, 16, v112
    v_lshlrev_b32 v47, 16, v120
    v_and_b32 v48, 0xffff0000, v112
    v_and_b32 v49, 0xffff0000, v120
    v_mul_f32 v46, v46, v47
    v_mul_f32 v48, v48, v49
    v_cvt_pk_bf16_f32 v46, v46, v48
    v_lshlrev_b32 v47, 16, v46
    v_and_b32 v48, 0xffff0000, v46
    v_add_f32 v44, v44, v47
    v_add_f32 v44, v44, v48
    v_lshlrev_b32 v46, 16, v113
    v_lshlrev_b32 v47, 16, v121
    v_and_b32 v48, 0xffff0000, v113
    v_and_b32 v49, 0xffff0000, v121
    v_mul_f32 v46, v46, v47
    v_mul_f32 v48, v48, v49
    v_cvt_pk_bf16_f32 v46, v46, v48
    v_lshlrev_b32 v47, 16, v46
    v_and_b32 v48, 0xffff0000, v46
    v_add_f32 v44, v44, v47
    v_add_f32 v44, v44, v48
    v_lshlrev_b32 v46, 16, v114
    v_lshlrev_b32 v47, 16, v122
    v_and_b32 v48, 0xffff0000, v114
    v_and_b32 v49, 0xffff0000, v122
    v_mul_f32 v46, v46, v47
    v_mul_f32 v48, v48, v49
    v_cvt_pk_bf16_f32 v46, v46, v48
    v_lshlrev_b32 v47, 16, v46
    v_and_b32 v48, 0xffff0000, v46
    v_add_f32 v44, v44, v47
    v_add_f32 v44, v44, v48
    v_lshlrev_b32 v46, 16, v115
    v_lshlrev_b32 v47, 16, v123
    v_and_b32 v48, 0xffff0000, v115
    v_and_b32 v49, 0xffff0000, v123
    v_mul_f32 v46, v46, v47
    v_mul_f32 v48, v48, v49
    v_cvt_pk_bf16_f32 v46, v46, v48
    v_lshlrev_b32 v47, 16, v46
    v_and_b32 v48, 0xffff0000, v46
    v_add_f32 v44, v44, v47
    v_add_f32 v44, v44, v48
    v_mov_b32 v45, 0
    v_lshlrev_b32 v46, 16, v116
    v_lshlrev_b32 v47, 16, v120
    v_and_b32 v48, 0xffff0000, v116
    v_and_b32 v49, 0xffff0000, v120
    v_mul_f32 v46, v46, v47
    v_mul_f32 v48, v48, v49
    v_cvt_pk_bf16_f32 v46, v46, v48
    v_lshlrev_b32 v47, 16, v46
    v_and_b32 v48, 0xffff0000, v46
    v_add_f32 v45, v45, v47
    v_add_f32 v45, v45, v48
    v_lshlrev_b32 v46, 16, v117
    v_lshlrev_b32 v47, 16, v121
    v_and_b32 v48, 0xffff0000, v117
    v_and_b32 v49, 0xffff0000, v121
    v_mul_f32 v46, v46, v47
    v_mul_f32 v48, v48, v49
    v_cvt_pk_bf16_f32 v46, v46, v48
    v_lshlrev_b32 v47, 16, v46
    v_and_b32 v48, 0xffff0000, v46
    v_add_f32 v45, v45, v47
    v_add_f32 v45, v45, v48
    v_lshlrev_b32 v46, 16, v118
    v_lshlrev_b32 v47, 16, v122
    v_and_b32 v48, 0xffff0000, v118
    v_and_b32 v49, 0xffff0000, v122
    v_mul_f32 v46, v46, v47
    v_mul_f32 v48, v48, v49
    v_cvt_pk_bf16_f32 v46, v46, v48
    v_lshlrev_b32 v47, 16, v46
    v_and_b32 v48, 0xffff0000, v46
    v_add_f32 v45, v45, v47
    v_add_f32 v45, v45, v48
    v_lshlrev_b32 v46, 16, v119
    v_lshlrev_b32 v47, 16, v123
    v_and_b32 v48, 0xffff0000, v119
    v_and_b32 v49, 0xffff0000, v123
    v_mul_f32 v46, v46, v47
    v_mul_f32 v48, v48, v49
    v_cvt_pk_bf16_f32 v46, v46, v48
    v_lshlrev_b32 v47, 16, v46
    v_and_b32 v48, 0xffff0000, v46
    v_add_f32 v45, v45, v47
    v_add_f32 v45, v45, v48
    v_add_f32_dpp v44, v44, v44 row_ror:8 row_mask:0xf bank_mask:0xf
    s_nop 0
    v_add_f32_dpp v45, v45, v45 row_ror:8 row_mask:0xf bank_mask:0xf
    v_add_f32_dpp v44, v44, v44 row_ror:4 row_mask:0xf bank_mask:0xf
    s_nop 0
    v_add_f32_dpp v45, v45, v45 row_ror:4 row_mask:0xf bank_mask:0xf
    v_add_f32_dpp v44, v44, v44 row_ror:2 row_mask:0xf bank_mask:0xf
    s_nop 0
    v_add_f32_dpp v45, v45, v45 row_ror:2 row_mask:0xf bank_mask:0xf
    v_add_f32_dpp v44, v44, v44 row_ror:1 row_mask:0xf bank_mask:0xf
    s_nop 0
    v_add_f32_dpp v45, v45, v45 row_ror:1 row_mask:0xf bank_mask:0xf
    v_mov_b32 v46, v44
    v_mov_b32 v47, v45
    s_nop 0
    v_permlane16_swap_b32 v44, v46
    v_permlane16_swap_b32 v45, v47
    v_add_f32 v44, v44, v46
    v_add_f32 v45, v45, v47
    v_mov_b32 v46, v44
    v_mov_b32 v47, v45
    s_nop 0
    v_permlane32_swap_b32 v44, v46
    v_permlane32_swap_b32 v45, v47
    v_add_f32 v44, v44, v46
    v_add_f32 v45, v45, v47
    v_cmp_gt_u32 vcc, 32, v0
    s_nop 1
    v_cndmask_b32 v44, v45, v44, vcc
    v_cvt_pk_bf16_f32 v44, v44, v44
    v_lshlrev_b32 v44, 16, v44
    v_mul_f32 v44, 0xbfb8aa3b, v44
    v_exp_f32 v44, v44
    s_nop 0
    v_add_f32 v44, 1.0, v44
    v_rcp_f32 v44, v44
    v_lshrrev_b32 v4, 5, v0
    v_lshlrev_b32 v4, 2, v4
    ds_write_b32 v4, v44 offset:288
    v_and_b32 v8, 7, v0
    v_mul_u32_u24 v8, 14336, v8
    v_bfe_u32 v9, v0, 3, 1
    v_mul_u32_u24 v10, 7168, v9
    v_add_u32 v8, v8, v10
    v_lshl_add_u32 v8, v3, 4, v8
    v_add_u32 v11, 64, v8
    v_cmp_eq_u32 vcc, 3, v3
    s_nop 1
    v_cndmask_b32 v11, v11, v8, vcc
    s_mul_i32 s72, s50, 112
    s_add_u32 s72, s72, 327680
    s_cmp_ge_u32 s85, 20
    s_cbranch_scc1 Lpe_44
Lp_43:
    ds_read_b32 v10, v1 offset:0
    s_waitcnt lgkmcnt(0)
    v_readfirstlane_b32 s85, v10
    s_nop 2
    s_cmp_ge_u32 s85, 20
    s_cbranch_scc1 Lpe_44
    s_sub_u32 s86, s86, 1
    s_cmp_gt_i32 s86, 0
    s_cbranch_scc1 Lp_43
Lpe_44:
    s_mov_b32 s101, 16384
Lg_45:
    buffer_load_dwordx4 v[64:67], v8, s[44:47], s72 offen sc1
    buffer_load_dwordx4 v[68:71], v11, s[44:47], s72 offen sc1
    s_waitcnt vmcnt(0)
    v_xor_b32 v64, s80, v64
    v_xor_b32 v65, s81, v65
    v_xor_b32 v66, s82, v66
    v_xor_b32 v67, s83, v67
    v_xor_b32 v68, s80, v68
    v_xor_b32 v69, s81, v69
    v_xor_b32 v70, s82, v70
    v_xor_b32 v71, s83, v71
    v_or3_b32 v72, v64, v65, v66
    v_or_b32 v72, v72, v67
    v_or3_b32 v72, v72, v68, v69
    v_or3_b32 v72, v72, v70, v71
    v_and_b32 v72, 0xff, v72
    v_cmp_ne_u32 vcc, 0, v72
    s_cbranch_vccz Lge_46
    s_sleep 4
    s_sub_u32 s101, s101, 1
    s_cmp_gt_i32 s101, 0
    s_cbranch_scc1 Lg_45
Lge_46:
    v_add_f32_dpp v64, v64, v64 quad_perm:[1,0,3,2] row_mask:0xf bank_mask:0xf
    v_add_f32_dpp v65, v65, v65 quad_perm:[1,0,3,2] row_mask:0xf bank_mask:0xf
    v_add_f32_dpp v66, v66, v66 quad_perm:[1,0,3,2] row_mask:0xf bank_mask:0xf
    v_add_f32_dpp v67, v67, v67 quad_perm:[1,0,3,2] row_mask:0xf bank_mask:0xf
    v_add_f32_dpp v68, v68, v68 quad_perm:[1,0,3,2] row_mask:0xf bank_mask:0xf
    v_add_f32_dpp v69, v69, v69 quad_perm:[1,0,3,2] row_mask:0xf bank_mask:0xf
    v_add_f32_dpp v70, v70, v70 quad_perm:[1,0,3,2] row_mask:0xf bank_mask:0xf
    v_add_f32_dpp v71, v71, v71 quad_perm:[1,0,3,2] row_mask:0xf bank_mask:0xf
    v_add_f32_dpp v64, v64, v64 quad_perm:[2,3,0,1] row_mask:0xf bank_mask:0xf
    v_add_f32_dpp v65, v65, v65 quad_perm:[2,3,0,1] row_mask:0xf bank_mask:0xf
    v_add_f32_dpp v66, v66, v66 quad_perm:[2,3,0,1] row_mask:0xf bank_mask:0xf
    v_add_f32_dpp v67, v67, v67 quad_perm:[2,3,0,1] row_mask:0xf bank_mask:0xf
    v_add_f32_dpp v68, v68, v68 quad_perm:[2,3,0,1] row_mask:0xf bank_mask:0xf
    v_add_f32_dpp v69, v69, v69 quad_perm:[2,3,0,1] row_mask:0xf bank_mask:0xf
    v_add_f32_dpp v70, v70, v70 quad_perm:[2,3,0,1] row_mask:0xf bank_mask:0xf
    v_add_f32_dpp v71, v71, v71 quad_perm:[2,3,0,1] row_mask:0xf bank_mask:0xf
    v_add_f32_dpp v64, v64, v64 row_half_mirror row_mask:0xf bank_mask:0xf
    v_add_f32_dpp v65, v65, v65 row_half_mirror row_mask:0xf bank_mask:0xf
    v_add_f32_dpp v66, v66, v66 row_half_mirror row_mask:0xf bank_mask:0xf
    v_add_f32_dpp v67, v67, v67 row_half_mirror row_mask:0xf bank_mask:0xf
    v_add_f32_dpp v68, v68, v68 row_half_mirror row_mask:0xf bank_mask:0xf
    v_add_f32_dpp v69, v69, v69 row_half_mirror row_mask:0xf bank_mask:0xf
    v_add_f32_dpp v70, v70, v70 row_half_mirror row_mask:0xf bank_mask:0xf
    v_add_f32_dpp v71, v71, v71 row_half_mirror row_mask:0xf bank_mask:0xf
    v_cvt_pk_bf16_f32 v64, v64, v65
    v_cvt_pk_bf16_f32 v66, v66, v67
    v_and_b32 v65, 0xffff0000, v64
    v_lshlrev_b32 v64, 16, v64
    v_and_b32 v67, 0xffff0000, v66
    v_lshlrev_b32 v66, 16, v66
    v_mul_f32 v80, 0xbfb8aa3b, v64
    v_exp_f32 v80, v80
    s_nop 0
    v_add_f32 v80, 1.0, v80
    v_rcp_f32 v80, v80
    s_nop 0
    v_mul_f32 v64, v64, v80
    v_mul_f32 v81, 0xbfb8aa3b, v65
    v_exp_f32 v81, v81
    s_nop 0
    v_add_f32 v81, 1.0, v81
    v_rcp_f32 v81, v81
    s_nop 0
    v_mul_f32 v65, v65, v81
    v_mul_f32 v82, 0xbfb8aa3b, v66
    v_exp_f32 v82, v82
    s_nop 0
    v_add_f32 v82, 1.0, v82
    v_rcp_f32 v82, v82
    s_nop 0
    v_mul_f32 v66, v66, v82
    v_mul_f32 v83, 0xbfb8aa3b, v67
    v_exp_f32 v83, v83
    s_nop 0
    v_add_f32 v83, 1.0, v83
    v_rcp_f32 v83, v83
    s_nop 0
    v_mul_f32 v67, v67, v83
    v_cvt_pk_bf16_f32 v64, v64, v65
    v_cvt_pk_bf16_f32 v65, v66, v67
    v_cvt_pk_bf16_f32 v68, v68, v69
    v_cvt_pk_bf16_f32 v70, v70, v71
    v_and_b32 v69, 0xffff0000, v68
    v_lshlrev_b32 v68, 16, v68
    v_and_b32 v71, 0xffff0000, v70
    v_lshlrev_b32 v70, 16, v70
    v_mul_f32 v80, 0xbfb8aa3b, v68
    v_exp_f32 v80, v80
    s_nop 0
    v_add_f32 v80, 1.0, v80
    v_rcp_f32 v80, v80
    s_nop 0
    v_mul_f32 v68, v68, v80
    v_mul_f32 v81, 0xbfb8aa3b, v69
    v_exp_f32 v81, v81
    s_nop 0
    v_add_f32 v81, 1.0, v81
    v_rcp_f32 v81, v81
    s_nop 0
    v_mul_f32 v69, v69, v81
    v_mul_f32 v82, 0xbfb8aa3b, v70
    v_exp_f32 v82, v82
    s_nop 0
    v_add_f32 v82, 1.0, v82
    v_rcp_f32 v82, v82
    s_nop 0
    v_mul_f32 v70, v70, v82
    v_mul_f32 v83, 0xbfb8aa3b, v71
    v_exp_f32 v83, v83
    s_nop 0
    v_add_f32 v83, 1.0, v83
    v_rcp_f32 v83, v83
    s_nop 0
    v_mul_f32 v71, v71, v83
    v_cvt_pk_bf16_f32 v68, v68, v69
    v_cvt_pk_bf16_f32 v69, v70, v71
    v_lshlrev_b32 v4, 4, v9
    v_lshl_add_u32 v4, v3, 5, v4
    s_mov_b32 s70, 0x01010101
    s_mov_b32 s71, 0x01010101
    s_mov_b64 exec, s[70:71]
    ds_write_b64 v4, v[64:65] offset:448
    s_mov_b32 s71, 0x00000101
    s_mov_b64 exec, s[70:71]
    ds_write_b64 v4, v[68:69] offset:456
    s_mov_b64 exec, -1
    v_mov_b32 v5, 1
    v_mov_b32 v4, 0
    ds_write_b32 v4, v5 offset:272
    s_endpgm

.p2align 12
L_loader_main:
    s_setprio 3
    s_load_dwordx2 s[16:17], s[0:1], 16
    s_load_dwordx2 s[24:25], s[0:1], 32
    s_load_dwordx2 s[32:33], s[0:1], 56
    s_mov_b32 s18, 0x8000000
    s_mov_b32 s19, 0x20000
    s_mov_b32 s26, 0x400000
    s_mov_b32 s27, 0x20000
    s_mov_b32 s34, 0x1c0000
    s_mov_b32 s35, 0x20000
    v_lshlrev_b32 v1, 2, v0
    s_lshr_b32 s50, s49, 2
    s_lshl_b32 s51, s48, 3
    s_add_u32 s50, s50, s51
    s_and_b32 s51, s49, 3
    s_mov_b32 s85, 0
    s_mov_b32 s86, 1048576
    s_mov_b32 s87, 0xff
    v_mov_b32 v10, 0
    ds_write_b32 v1, v10 offset:0
    ds_write_b32 v1, v10 offset:256
    ds_write_b32 v1, v10 offset:512
    v_lshlrev_b32 v5, 1, v3
    v_xor_b32 v5, v5, v2
    v_lshl_add_u32 v24, v5, 4, v4
    v_xor_b32 v25, 128, v24
    v_lshlrev_b32 v5, 4, v5
    v_lshl_add_u32 v26, v3, 10, v5
    v_xor_b32 v27, 128, v26
    v_mov_b32 v12, 0
    v_mov_b32 v13, 0
    v_mov_b32 v14, 0
    v_mov_b32 v15, 0
    v_lshlrev_b32 v5, 4, v0
    ds_write_b128 v5, v[12:15] offset:27648
    s_lshl_b32 s60, s50, 16
    s_lshl_b32 s61, s51, 8
    s_add_u32 s60, s60, s61
    s_mul_i32 s62, s50, 28672
    s_add_u32 s62, s62, s61
    s_mul_i32 s65, s50, 2

    s_waitcnt lgkmcnt(0)
    s_barrier
    s_add_u32 s63, s56, 3
    s_and_b32 s63, s63, 15
    s_lshl_b32 s63, s63, 12
    s_add_u32 s63, s63, s54
    s_mov_b32 m0, 40960
    s_nop 0
    buffer_load_dwordx4 v20, s[12:15], s63 offen offset:0 nt lds
    buffer_load_dwordx4 v21, s[12:15], s63 offen offset:1024 nt lds
    buffer_load_dwordx4 v22, s[12:15], s63 offen offset:2048 nt lds
    buffer_load_dwordx4 v23, s[12:15], s63 offen offset:3072 nt lds
    s_add_u32 s63, s56, 4
    s_and_b32 s63, s63, 15
    s_lshl_b32 s63, s63, 12
    s_add_u32 s63, s63, s54
    s_mov_b32 m0, 45056
    s_nop 0
    buffer_load_dwordx4 v20, s[12:15], s63 offen offset:0 nt lds
    buffer_load_dwordx4 v21, s[12:15], s63 offen offset:1024 nt lds
    buffer_load_dwordx4 v22, s[12:15], s63 offen offset:2048 nt lds
    buffer_load_dwordx4 v23, s[12:15], s63 offen offset:3072 nt lds
    s_add_u32 s63, s56, 5
    s_and_b32 s63, s63, 15
    s_lshl_b32 s63, s63, 12
    s_add_u32 s63, s63, s54
    s_mov_b32 m0, 49152
    s_nop 0
    buffer_load_dwordx4 v20, s[12:15], s63 offen offset:0 nt lds
    buffer_load_dwordx4 v21, s[12:15], s63 offen offset:1024 nt lds
    buffer_load_dwordx4 v22, s[12:15], s63 offen offset:2048 nt lds
    buffer_load_dwordx4 v23, s[12:15], s63 offen offset:3072 nt lds
    s_add_u32 s63, s56, 6
    s_and_b32 s63, s63, 15
    s_lshl_b32 s63, s63, 12
    s_add_u32 s63, s63, s54
    s_waitcnt vmcnt(23)
    s_mov_b32 m0, 53248
    s_nop 0
    buffer_load_dwordx4 v20, s[12:15], s63 offen offset:0 nt lds
    s_waitcnt vmcnt(23)
    buffer_load_dwordx4 v21, s[12:15], s63 offen offset:1024 nt lds
    s_waitcnt vmcnt(23)
    buffer_load_dwordx4 v22, s[12:15], s63 offen offset:2048 nt lds
    s_waitcnt vmcnt(23)
    v_mov_b32 v10, 1
    ds_write_b32 v1, v10 offset:0
    buffer_load_dwordx4 v23, s[12:15], s63 offen offset:3072 nt lds
    s_add_u32 s63, s56, 7
    s_and_b32 s63, s63, 15
    s_lshl_b32 s63, s63, 12
    s_add_u32 s63, s63, s54
    s_waitcnt vmcnt(23)
    s_mov_b32 m0, 57344
    s_nop 0
    buffer_load_dwordx4 v20, s[12:15], s63 offen offset:0 nt lds
    s_waitcnt vmcnt(23)
    buffer_load_dwordx4 v21, s[12:15], s63 offen offset:1024 nt lds
    s_waitcnt vmcnt(23)
    buffer_load_dwordx4 v22, s[12:15], s63 offen offset:2048 nt lds
    s_waitcnt vmcnt(23)
    v_mov_b32 v10, 2
    ds_write_b32 v1, v10 offset:0
    buffer_load_dwordx4 v23, s[12:15], s63 offen offset:3072 nt lds
    s_add_u32 s63, s56, 8
    s_and_b32 s63, s63, 15
    s_lshl_b32 s63, s63, 12
    s_add_u32 s63, s63, s54
    s_waitcnt vmcnt(23)
    s_mov_b32 m0, 61440
    s_nop 0
    buffer_load_dwordx4 v20, s[12:15], s63 offen offset:0 nt lds
    s_waitcnt vmcnt(23)
    buffer_load_dwordx4 v21, s[12:15], s63 offen offset:1024 nt lds
    s_waitcnt vmcnt(23)
    buffer_load_dwordx4 v22, s[12:15], s63 offen offset:2048 nt lds
    s_waitcnt vmcnt(23)
    v_mov_b32 v10, 3
    ds_write_b32 v1, v10 offset:0
    buffer_load_dwordx4 v23, s[12:15], s63 offen offset:3072 nt lds
    s_add_u32 s63, s56, 9
    s_and_b32 s63, s63, 15
    s_lshl_b32 s63, s63, 12
    s_add_u32 s63, s63, s54
    s_waitcnt vmcnt(23)
    s_mov_b32 m0, 65536
    s_nop 0
    buffer_load_dwordx4 v20, s[12:15], s63 offen offset:0 nt lds
    s_waitcnt vmcnt(23)
    buffer_load_dwordx4 v21, s[12:15], s63 offen offset:1024 nt lds
    s_waitcnt vmcnt(23)
    buffer_load_dwordx4 v22, s[12:15], s63 offen offset:2048 nt lds
    s_waitcnt vmcnt(23)
    v_mov_b32 v10, 4
    ds_write_b32 v1, v10 offset:0
    buffer_load_dwordx4 v23, s[12:15], s63 offen offset:3072 nt lds
    s_add_u32 s63, s56, 10
    s_and_b32 s63, s63, 15
    s_lshl_b32 s63, s63, 12
    s_add_u32 s63, s63, s54
    s_waitcnt vmcnt(23)
    s_mov_b32 m0, 69632
    s_nop 0
    buffer_load_dwordx4 v20, s[12:15], s63 offen offset:0 nt lds
    s_waitcnt vmcnt(23)
    buffer_load_dwordx4 v21, s[12:15], s63 offen offset:1024 nt lds
    s_waitcnt vmcnt(23)
    buffer_load_dwordx4 v22, s[12:15], s63 offen offset:2048 nt lds
    s_waitcnt vmcnt(23)
    v_mov_b32 v10, 5
    ds_write_b32 v1, v10 offset:0
    buffer_load_dwordx4 v23, s[12:15], s63 offen offset:3072 nt lds
    s_add_u32 s63, s56, 11
    s_and_b32 s63, s63, 15
    s_lshl_b32 s63, s63, 12
    s_add_u32 s63, s63, s54
    s_waitcnt vmcnt(23)
    s_mov_b32 m0, 73728
    s_nop 0
    buffer_load_dwordx4 v20, s[12:15], s63 offen offset:0 nt lds
    s_waitcnt vmcnt(23)
    buffer_load_dwordx4 v21, s[12:15], s63 offen offset:1024 nt lds
    s_waitcnt vmcnt(23)
    buffer_load_dwordx4 v22, s[12:15], s63 offen offset:2048 nt lds
    s_waitcnt vmcnt(23)
    v_mov_b32 v10, 6
    ds_write_b32 v1, v10 offset:0
    buffer_load_dwordx4 v23, s[12:15], s63 offen offset:3072 nt lds
    s_add_u32 s63, s56, 12
    s_and_b32 s63, s63, 15
    s_lshl_b32 s63, s63, 12
    s_add_u32 s63, s63, s54
    s_waitcnt vmcnt(23)
    s_mov_b32 m0, 77824
    s_nop 0
    buffer_load_dwordx4 v20, s[12:15], s63 offen offset:0 nt lds
    s_waitcnt vmcnt(23)
    buffer_load_dwordx4 v21, s[12:15], s63 offen offset:1024 nt lds
    s_waitcnt vmcnt(23)
    buffer_load_dwordx4 v22, s[12:15], s63 offen offset:2048 nt lds
    s_waitcnt vmcnt(23)
    v_mov_b32 v10, 7
    ds_write_b32 v1, v10 offset:0
    buffer_load_dwordx4 v23, s[12:15], s63 offen offset:3072 nt lds
    s_add_u32 s63, s56, 13
    s_and_b32 s63, s63, 15
    s_lshl_b32 s63, s63, 12
    s_add_u32 s63, s63, s54
    s_waitcnt vmcnt(23)
    s_mov_b32 m0, 81920
    s_nop 0
    buffer_load_dwordx4 v20, s[12:15], s63 offen offset:0 nt lds
    s_waitcnt vmcnt(23)
    buffer_load_dwordx4 v21, s[12:15], s63 offen offset:1024 nt lds
    s_waitcnt vmcnt(23)
    buffer_load_dwordx4 v22, s[12:15], s63 offen offset:2048 nt lds
    s_waitcnt vmcnt(23)
    v_mov_b32 v10, 8
    ds_write_b32 v1, v10 offset:0
    buffer_load_dwordx4 v23, s[12:15], s63 offen offset:3072 nt lds
    s_add_u32 s63, s56, 14
    s_and_b32 s63, s63, 15
    s_lshl_b32 s63, s63, 12
    s_add_u32 s63, s63, s54
    s_waitcnt vmcnt(23)
    s_mov_b32 m0, 86016
    s_nop 0
    buffer_load_dwordx4 v20, s[12:15], s63 offen offset:0 nt lds
    s_waitcnt vmcnt(23)
    buffer_load_dwordx4 v21, s[12:15], s63 offen offset:1024 nt lds
    s_waitcnt vmcnt(23)
    buffer_load_dwordx4 v22, s[12:15], s63 offen offset:2048 nt lds
    s_waitcnt vmcnt(23)
    v_mov_b32 v10, 9
    ds_write_b32 v1, v10 offset:0
    buffer_load_dwordx4 v23, s[12:15], s63 offen offset:3072 nt lds
    s_add_u32 s63, s56, 15
    s_and_b32 s63, s63, 15
    s_lshl_b32 s63, s63, 12
    s_add_u32 s63, s63, s54
    s_waitcnt vmcnt(23)
    s_mov_b32 m0, 90112
    s_nop 0
    buffer_load_dwordx4 v20, s[12:15], s63 offen offset:0 nt lds
    s_waitcnt vmcnt(23)
    buffer_load_dwordx4 v21, s[12:15], s63 offen offset:1024 nt lds
    s_waitcnt vmcnt(23)
    buffer_load_dwordx4 v22, s[12:15], s63 offen offset:2048 nt lds
    s_waitcnt vmcnt(23)
    v_mov_b32 v10, 10
    ds_write_b32 v1, v10 offset:0
    buffer_load_dwordx4 v23, s[12:15], s63 offen offset:3072 nt lds
    s_add_u32 s63, s56, 0
    s_and_b32 s63, s63, 15
    s_lshl_b32 s63, s63, 12
    s_add_u32 s63, s63, s54
    s_waitcnt vmcnt(23)
    s_mov_b32 m0, 94208
    s_nop 0
    buffer_load_dwordx4 v24, s[16:19], s63 offen offset:0 nt lds
    s_waitcnt vmcnt(23)
    buffer_load_dwordx4 v25, s[16:19], s63 offen offset:1024 nt lds
    s_waitcnt vmcnt(23)
    buffer_load_dwordx4 v24, s[16:19], s63 offen offset:2048 nt lds
    s_waitcnt vmcnt(23)
    v_mov_b32 v10, 11
    ds_write_b32 v1, v10 offset:0
    buffer_load_dwordx4 v25, s[16:19], s63 offen offset:3072 nt lds
    s_add_u32 s63, s56, 1
    s_and_b32 s63, s63, 15
    s_lshl_b32 s63, s63, 12
    s_add_u32 s63, s63, s54
    s_waitcnt vmcnt(23)
    s_mov_b32 m0, 98304
    s_nop 0
    buffer_load_dwordx4 v24, s[16:19], s63 offen offset:0 nt lds
    s_waitcnt vmcnt(23)
    buffer_load_dwordx4 v25, s[16:19], s63 offen offset:1024 nt lds
    s_waitcnt vmcnt(23)
    buffer_load_dwordx4 v24, s[16:19], s63 offen offset:2048 nt lds
    s_waitcnt vmcnt(23)
    v_mov_b32 v10, 12
    ds_write_b32 v1, v10 offset:0
    buffer_load_dwordx4 v25, s[16:19], s63 offen offset:3072 nt lds
    s_add_u32 s63, s56, 2
    s_and_b32 s63, s63, 15
    s_lshl_b32 s63, s63, 12
    s_add_u32 s63, s63, s54
    s_waitcnt vmcnt(23)
    s_mov_b32 m0, 102400
    s_nop 0
    buffer_load_dwordx4 v24, s[16:19], s63 offen offset:0 nt lds
    s_waitcnt vmcnt(23)
    buffer_load_dwordx4 v25, s[16:19], s63 offen offset:1024 nt lds
    s_waitcnt vmcnt(23)
    buffer_load_dwordx4 v24, s[16:19], s63 offen offset:2048 nt lds
    s_waitcnt vmcnt(23)
    v_mov_b32 v10, 13
    ds_write_b32 v1, v10 offset:0
    buffer_load_dwordx4 v25, s[16:19], s63 offen offset:3072 nt lds
    s_add_u32 s63, s56, 3
    s_and_b32 s63, s63, 15
    s_lshl_b32 s63, s63, 12
    s_add_u32 s63, s63, s54
    s_waitcnt vmcnt(23)
    s_mov_b32 m0, 106496
    s_nop 0
    buffer_load_dwordx4 v24, s[16:19], s63 offen offset:0 nt lds
    s_waitcnt vmcnt(23)
    buffer_load_dwordx4 v25, s[16:19], s63 offen offset:1024 nt lds
    s_waitcnt vmcnt(23)
    buffer_load_dwordx4 v24, s[16:19], s63 offen offset:2048 nt lds
    s_waitcnt vmcnt(23)
    v_mov_b32 v10, 14
    ds_write_b32 v1, v10 offset:0
    buffer_load_dwordx4 v25, s[16:19], s63 offen offset:3072 nt lds
    s_add_u32 s63, s56, 4
    s_and_b32 s63, s63, 15
    s_lshl_b32 s63, s63, 12
    s_add_u32 s63, s63, s54
    s_waitcnt vmcnt(23)
    s_mov_b32 m0, 110592
    s_nop 0
    buffer_load_dwordx4 v24, s[16:19], s63 offen offset:0 nt lds
    s_waitcnt vmcnt(23)
    buffer_load_dwordx4 v25, s[16:19], s63 offen offset:1024 nt lds
    s_waitcnt vmcnt(23)
    buffer_load_dwordx4 v24, s[16:19], s63 offen offset:2048 nt lds
    s_waitcnt vmcnt(23)
    v_mov_b32 v10, 15
    ds_write_b32 v1, v10 offset:0
    buffer_load_dwordx4 v25, s[16:19], s63 offen offset:3072 nt lds
    s_add_u32 s63, s56, 5
    s_and_b32 s63, s63, 15
    s_lshl_b32 s63, s63, 12
    s_add_u32 s63, s63, s54
    s_waitcnt vmcnt(23)
    s_mov_b32 m0, 114688
    s_nop 0
    buffer_load_dwordx4 v24, s[16:19], s63 offen offset:0 nt lds
    s_waitcnt vmcnt(23)
    buffer_load_dwordx4 v25, s[16:19], s63 offen offset:1024 nt lds
    s_waitcnt vmcnt(23)
    buffer_load_dwordx4 v24, s[16:19], s63 offen offset:2048 nt lds
    s_waitcnt vmcnt(23)
    v_mov_b32 v10, 16
    ds_write_b32 v1, v10 offset:0
    buffer_load_dwordx4 v25, s[16:19], s63 offen offset:3072 nt lds
    s_add_u32 s63, s56, 6
    s_and_b32 s63, s63, 15
    s_lshl_b32 s63, s63, 12
    s_add_u32 s63, s63, s54
    s_waitcnt vmcnt(23)
    s_mov_b32 m0, 118784
    s_nop 0
    buffer_load_dwordx4 v24, s[16:19], s63 offen offset:0 nt lds
    s_waitcnt vmcnt(23)
    buffer_load_dwordx4 v25, s[16:19], s63 offen offset:1024 nt lds
    s_waitcnt vmcnt(23)
    buffer_load_dwordx4 v24, s[16:19], s63 offen offset:2048 nt lds
    s_waitcnt vmcnt(23)
    v_mov_b32 v10, 17
    ds_write_b32 v1, v10 offset:0
    buffer_load_dwordx4 v25, s[16:19], s63 offen offset:3072 nt lds
    s_add_u32 s63, s56, 7
    s_and_b32 s63, s63, 15
    s_lshl_b32 s63, s63, 12
    s_add_u32 s63, s63, s54
    s_waitcnt vmcnt(23)
    s_mov_b32 m0, 122880
    s_nop 0
    buffer_load_dwordx4 v24, s[16:19], s63 offen offset:0 nt lds
    s_waitcnt vmcnt(23)
    buffer_load_dwordx4 v25, s[16:19], s63 offen offset:1024 nt lds
    s_waitcnt vmcnt(23)
    buffer_load_dwordx4 v24, s[16:19], s63 offen offset:2048 nt lds
    s_waitcnt vmcnt(23)
    v_mov_b32 v10, 18
    ds_write_b32 v1, v10 offset:0
    buffer_load_dwordx4 v25, s[16:19], s63 offen offset:3072 nt lds
    s_add_u32 s63, s56, 8
    s_and_b32 s63, s63, 15
    s_lshl_b32 s63, s63, 12
    s_add_u32 s63, s63, s54
    s_waitcnt vmcnt(23)
    s_mov_b32 m0, 126976
    s_nop 0
    buffer_load_dwordx4 v24, s[16:19], s63 offen offset:0 nt lds
    s_waitcnt vmcnt(23)
    buffer_load_dwordx4 v25, s[16:19], s63 offen offset:1024 nt lds
    s_waitcnt vmcnt(23)
    buffer_load_dwordx4 v24, s[16:19], s63 offen offset:2048 nt lds
    s_waitcnt vmcnt(23)
    v_mov_b32 v10, 19
    ds_write_b32 v1, v10 offset:0
    buffer_load_dwordx4 v25, s[16:19], s63 offen offset:3072 nt lds
    s_add_u32 s63, s56, 9
    s_and_b32 s63, s63, 15
    s_lshl_b32 s63, s63, 12
    s_add_u32 s63, s63, s54
    s_waitcnt vmcnt(23)
    s_mov_b32 m0, 131072
    s_nop 0
    buffer_load_dwordx4 v24, s[16:19], s63 offen offset:0 nt lds
    s_waitcnt vmcnt(23)
    buffer_load_dwordx4 v25, s[16:19], s63 offen offset:1024 nt lds
    s_waitcnt vmcnt(23)
    buffer_load_dwordx4 v24, s[16:19], s63 offen offset:2048 nt lds
    s_waitcnt vmcnt(23)
    v_mov_b32 v10, 20
    ds_write_b32 v1, v10 offset:0
    buffer_load_dwordx4 v25, s[16:19], s63 offen offset:3072 nt lds
    s_add_u32 s63, s56, 10
    s_and_b32 s63, s63, 15
    s_lshl_b32 s63, s63, 12
    s_add_u32 s63, s63, s54
    s_waitcnt vmcnt(23)
    s_mov_b32 m0, 135168
    s_nop 0
    buffer_load_dwordx4 v24, s[16:19], s63 offen offset:0 nt lds
    s_waitcnt vmcnt(23)
    buffer_load_dwordx4 v25, s[16:19], s63 offen offset:1024 nt lds
    s_waitcnt vmcnt(23)
    buffer_load_dwordx4 v24, s[16:19], s63 offen offset:2048 nt lds
    s_waitcnt vmcnt(23)
    v_mov_b32 v10, 21
    ds_write_b32 v1, v10 offset:0
    buffer_load_dwordx4 v25, s[16:19], s63 offen offset:3072 nt lds
    s_add_u32 s63, s56, 11
    s_and_b32 s63, s63, 15
    s_lshl_b32 s63, s63, 12
    s_add_u32 s63, s63, s54
    s_waitcnt vmcnt(23)
    s_mov_b32 m0, 139264
    s_nop 0
    buffer_load_dwordx4 v24, s[16:19], s63 offen offset:0 nt lds
    s_waitcnt vmcnt(23)
    buffer_load_dwordx4 v25, s[16:19], s63 offen offset:1024 nt lds
    s_waitcnt vmcnt(23)
    buffer_load_dwordx4 v24, s[16:19], s63 offen offset:2048 nt lds
    s_waitcnt vmcnt(23)
    v_mov_b32 v10, 22
    ds_write_b32 v1, v10 offset:0
    buffer_load_dwordx4 v25, s[16:19], s63 offen offset:3072 nt lds
    s_add_u32 s63, s56, 12
    s_and_b32 s63, s63, 15
    s_lshl_b32 s63, s63, 12
    s_add_u32 s63, s63, s54
    s_waitcnt vmcnt(23)
    s_mov_b32 m0, 143360
    s_nop 0
    buffer_load_dwordx4 v24, s[16:19], s63 offen offset:0 nt lds
    s_waitcnt vmcnt(23)
    buffer_load_dwordx4 v25, s[16:19], s63 offen offset:1024 nt lds
    s_waitcnt vmcnt(23)
    buffer_load_dwordx4 v24, s[16:19], s63 offen offset:2048 nt lds
    s_waitcnt vmcnt(23)
    v_mov_b32 v10, 23
    ds_write_b32 v1, v10 offset:0
    buffer_load_dwordx4 v25, s[16:19], s63 offen offset:3072 nt lds
    s_add_u32 s63, s56, 13
    s_and_b32 s63, s63, 15
    s_lshl_b32 s63, s63, 12
    s_add_u32 s63, s63, s54
    s_waitcnt vmcnt(23)
    s_mov_b32 m0, 147456
    s_nop 0
    buffer_load_dwordx4 v24, s[16:19], s63 offen offset:0 nt lds
    s_waitcnt vmcnt(23)
    buffer_load_dwordx4 v25, s[16:19], s63 offen offset:1024 nt lds
    s_waitcnt vmcnt(23)
    buffer_load_dwordx4 v24, s[16:19], s63 offen offset:2048 nt lds
    s_waitcnt vmcnt(23)
    v_mov_b32 v10, 24
    ds_write_b32 v1, v10 offset:0
    buffer_load_dwordx4 v25, s[16:19], s63 offen offset:3072 nt lds
    s_add_u32 s63, s56, 14
    s_and_b32 s63, s63, 15
    s_lshl_b32 s63, s63, 12
    s_add_u32 s63, s63, s54
    s_waitcnt vmcnt(23)
    s_mov_b32 m0, 151552
    s_nop 0
    buffer_load_dwordx4 v24, s[16:19], s63 offen offset:0 nt lds
    s_waitcnt vmcnt(23)
    buffer_load_dwordx4 v25, s[16:19], s63 offen offset:1024 nt lds
    s_waitcnt vmcnt(23)
    buffer_load_dwordx4 v24, s[16:19], s63 offen offset:2048 nt lds
    s_waitcnt vmcnt(23)
    v_mov_b32 v10, 25
    ds_write_b32 v1, v10 offset:0
    buffer_load_dwordx4 v25, s[16:19], s63 offen offset:3072 nt lds
    s_add_u32 s63, s56, 15
    s_and_b32 s63, s63, 15
    s_lshl_b32 s63, s63, 12
    s_add_u32 s63, s63, s54
    s_waitcnt vmcnt(23)
    s_mov_b32 m0, 155648
    s_nop 0
    buffer_load_dwordx4 v24, s[16:19], s63 offen offset:0 nt lds
    s_waitcnt vmcnt(23)
    buffer_load_dwordx4 v25, s[16:19], s63 offen offset:1024 nt lds
    s_waitcnt vmcnt(23)
    buffer_load_dwordx4 v24, s[16:19], s63 offen offset:2048 nt lds
    s_waitcnt vmcnt(23)
    v_mov_b32 v10, 26
    ds_write_b32 v1, v10 offset:0
    buffer_load_dwordx4 v25, s[16:19], s63 offen offset:3072 nt lds
    s_add_u32 s63, s62, 0
    s_waitcnt vmcnt(23)
    s_mov_b32 m0, 20480
    s_nop 0
    buffer_load_dwordx4 v26, s[32:35], s63 offen nt lds
    s_add_u32 s63, s62, 4096
    s_waitcnt vmcnt(23)
    s_mov_b32 m0, 21504
    s_nop 0
    buffer_load_dwordx4 v27, s[32:35], s63 offen nt lds
    s_add_u32 s63, s62, 8192
    s_waitcnt vmcnt(23)
    s_mov_b32 m0, 22528
    s_nop 0
    buffer_load_dwordx4 v26, s[32:35], s63 offen nt lds
    s_add_u32 s63, s62, 12288
    s_waitcnt vmcnt(23)
    v_mov_b32 v10, 27
    ds_write_b32 v1, v10 offset:0
    s_mov_b32 m0, 23552
    s_nop 0
    buffer_load_dwordx4 v27, s[32:35], s63 offen nt lds
    s_add_u32 s63, s62, 16384
    s_waitcnt vmcnt(23)
    s_mov_b32 m0, 24576
    s_nop 0
    buffer_load_dwordx4 v26, s[32:35], s63 offen nt lds
    s_add_u32 s63, s62, 20480
    s_waitcnt vmcnt(23)
    s_mov_b32 m0, 25600
    s_nop 0
    buffer_load_dwordx4 v27, s[32:35], s63 offen nt lds
    s_add_u32 s63, s62, 24576
    s_waitcnt vmcnt(23)
    s_mov_b32 m0, 26624
    s_nop 0
    buffer_load_dwordx4 v26, s[32:35], s63 offen nt lds
    s_add_u32 s63, s65, 0
    s_and_b32 s63, s63, 15
    s_lshl_b32 s64, s63, 10
    s_lshl_b32 s63, s63, 12
    s_add_u32 s63, s63, s60
    s_waitcnt vmcnt(23)
    v_mov_b32 v10, 28
    ds_write_b32 v1, v10 offset:0
    s_add_u32 m0, s64, 4096
    s_nop 0
    buffer_load_dwordx4 v26, s[24:27], s63 offen nt lds
    s_add_u32 s63, s65, 1
    s_and_b32 s63, s63, 15
    s_lshl_b32 s64, s63, 10
    s_lshl_b32 s63, s63, 12
    s_add_u32 s63, s63, s60
    s_waitcnt vmcnt(23)
    s_add_u32 m0, s64, 4096
    s_nop 0
    buffer_load_dwordx4 v27, s[24:27], s63 offen nt lds
    s_add_u32 s63, s65, 2
    s_and_b32 s63, s63, 15
    s_lshl_b32 s64, s63, 10
    s_lshl_b32 s63, s63, 12
    s_add_u32 s63, s63, s60
    s_waitcnt vmcnt(23)
    s_add_u32 m0, s64, 4096
    s_nop 0
    buffer_load_dwordx4 v26, s[24:27], s63 offen nt lds
    s_add_u32 s63, s65, 3
    s_and_b32 s63, s63, 15
    s_lshl_b32 s64, s63, 10
    s_lshl_b32 s63, s63, 12
    s_add_u32 s63, s63, s60
    s_waitcnt vmcnt(23)
    s_add_u32 m0, s64, 4096
    s_nop 0
    buffer_load_dwordx4 v27, s[24:27], s63 offen nt lds
    s_add_u32 s63, s65, 4
    s_and_b32 s63, s63, 15
    s_lshl_b32 s64, s63, 10
    s_lshl_b32 s63, s63, 12
    s_add_u32 s63, s63, s60
    s_waitcnt vmcnt(23)
    v_mov_b32 v10, 29
    ds_write_b32 v1, v10 offset:0
    s_add_u32 m0, s64, 4096
    s_nop 0
    buffer_load_dwordx4 v26, s[24:27], s63 offen nt lds
    s_add_u32 s63, s65, 5
    s_and_b32 s63, s63, 15
    s_lshl_b32 s64, s63, 10
    s_lshl_b32 s63, s63, 12
    s_add_u32 s63, s63, s60
    s_waitcnt vmcnt(23)
    s_add_u32 m0, s64, 4096
    s_nop 0
    buffer_load_dwordx4 v27, s[24:27], s63 offen nt lds
    s_add_u32 s63, s65, 6
    s_and_b32 s63, s63, 15
    s_lshl_b32 s64, s63, 10
    s_lshl_b32 s63, s63, 12
    s_add_u32 s63, s63, s60
    s_waitcnt vmcnt(23)
    s_add_u32 m0, s64, 4096
    s_nop 0
    buffer_load_dwordx4 v26, s[24:27], s63 offen nt lds
    s_add_u32 s63, s65, 7
    s_and_b32 s63, s63, 15
    s_lshl_b32 s64, s63, 10
    s_lshl_b32 s63, s63, 12
    s_add_u32 s63, s63, s60
    s_waitcnt vmcnt(23)
    s_add_u32 m0, s64, 4096
    s_nop 0
    buffer_load_dwordx4 v27, s[24:27], s63 offen nt lds
    s_add_u32 s63, s65, 8
    s_and_b32 s63, s63, 15
    s_lshl_b32 s64, s63, 10
    s_lshl_b32 s63, s63, 12
    s_add_u32 s63, s63, s60
    s_waitcnt vmcnt(23)
    v_mov_b32 v10, 30
    ds_write_b32 v1, v10 offset:0
    s_add_u32 m0, s64, 4096
    s_nop 0
    buffer_load_dwordx4 v26, s[24:27], s63 offen nt lds
    s_add_u32 s63, s65, 9
    s_and_b32 s63, s63, 15
    s_lshl_b32 s64, s63, 10
    s_lshl_b32 s63, s63, 12
    s_add_u32 s63, s63, s60
    s_waitcnt vmcnt(23)
    s_add_u32 m0, s64, 4096
    s_nop 0
    buffer_load_dwordx4 v27, s[24:27], s63 offen nt lds
    s_add_u32 s63, s65, 10
    s_and_b32 s63, s63, 15
    s_lshl_b32 s64, s63, 10
    s_lshl_b32 s63, s63, 12
    s_add_u32 s63, s63, s60
    s_waitcnt vmcnt(23)
    s_add_u32 m0, s64, 4096
    s_nop 0
    buffer_load_dwordx4 v26, s[24:27], s63 offen nt lds
    s_add_u32 s63, s65, 11
    s_and_b32 s63, s63, 15
    s_lshl_b32 s64, s63, 10
    s_lshl_b32 s63, s63, 12
    s_add_u32 s63, s63, s60
    s_waitcnt vmcnt(23)
    s_add_u32 m0, s64, 4096
    s_nop 0
    buffer_load_dwordx4 v27, s[24:27], s63 offen nt lds
    s_add_u32 s63, s65, 12
    s_and_b32 s63, s63, 15
    s_lshl_b32 s64, s63, 10
    s_lshl_b32 s63, s63, 12
    s_add_u32 s63, s63, s60
    s_waitcnt vmcnt(23)
    v_mov_b32 v10, 31
    ds_write_b32 v1, v10 offset:0
    s_add_u32 m0, s64, 4096
    s_nop 0
    buffer_load_dwordx4 v26, s[24:27], s63 offen nt lds
    s_add_u32 s63, s65, 13
    s_and_b32 s63, s63, 15
    s_lshl_b32 s64, s63, 10
    s_lshl_b32 s63, s63, 12
    s_add_u32 s63, s63, s60
    s_waitcnt vmcnt(23)
    s_add_u32 m0, s64, 4096
    s_nop 0
    buffer_load_dwordx4 v27, s[24:27], s63 offen nt lds
    s_add_u32 s63, s65, 14
    s_and_b32 s63, s63, 15
    s_lshl_b32 s64, s63, 10
    s_lshl_b32 s63, s63, 12
    s_add_u32 s63, s63, s60
    s_waitcnt vmcnt(23)
    s_add_u32 m0, s64, 4096
    s_nop 0
    buffer_load_dwordx4 v26, s[24:27], s63 offen nt lds
    s_add_u32 s63, s65, 15
    s_and_b32 s63, s63, 15
    s_lshl_b32 s64, s63, 10
    s_lshl_b32 s63, s63, 12
    s_add_u32 s63, s63, s60
    s_waitcnt vmcnt(23)
    s_add_u32 m0, s64, 4096
    s_nop 0
    buffer_load_dwordx4 v27, s[24:27], s63 offen nt lds
    s_waitcnt vmcnt(23)
    v_mov_b32 v10, 32
    ds_write_b32 v1, v10 offset:0
    s_waitcnt vmcnt(0)
    v_mov_b32 v10, 32
    ds_write_b32 v1, v10 offset:0
    s_endpgm
L_end:
    s_endpgm

.section .rodata,"a"
.p2align 6
.amdhsa_kernel gated_mix__sliding_block_cached__dense_activation_silu__decode_kernel
  .amdhsa_next_free_vgpr 144
  .amdhsa_next_free_sgpr 102
  .amdhsa_accum_offset 144
  .amdhsa_group_segment_fixed_size 0
  .amdhsa_kernarg_size 96
  .amdhsa_user_sgpr_count 2
  .amdhsa_user_sgpr_kernarg_segment_ptr 1
  .amdhsa_system_sgpr_workgroup_id_x 1
.end_amdhsa_kernel
```
